```python
import torch

def _softmax(x, axis=-1):
    return torch.softmax(x, dim=axis)
def _gelu(x):
    return torch.nn.functional.gelu(x, approximate="tanh")
def _silu(x):
    return torch.nn.functional.silu(x)
def _sigmoid(x):
    return torch.sigmoid(x)
def _layernorm(x, axis=-1, eps=1e-5):
    m = x.mean(dim=axis, keepdim=True)
    v = x.var(dim=axis, keepdim=True, unbiased=False)
    return (x - m) / torch.sqrt(v + eps)
def _scatter_add(tgt, idx, src, axis=0):
    return tgt.clone().index_add_(axis, idx, src)
def _segment_sum(src, seg, n):
    out = torch.zeros((n,) + src.shape[1:], dtype=src.dtype)
    return out.index_add_(0, seg, src)
def _pad(x, pw):
    flat = tuple(v for pair in reversed(pw) for v in pair)
    return torch.nn.functional.pad(x, flat)

kernel_name = 'sequential_preLN__mha_block_cached__dense_activation_gelu__decode'

def setup_inputs():

    _w = (lambda a: (lambda t: t.to(torch.bfloat16) if t.is_floating_point() else t)(torch.as_tensor(a)))
    def _A_setup():
        B, Sq, D = 1, 1, 640
        H, Sk, Dh = 32, 32768, 128
        return {
            "x": _w((lambda *s: torch.randn(*s, dtype=torch.bfloat16) * 0.1)(B, Sq, D)),
            "k_cache": _w((lambda *s: torch.randn(*s, dtype=torch.bfloat16) * 1.6)(B, H, Sk, Dh)),
            "v_cache": _w((lambda *s: torch.randn(*s, dtype=torch.bfloat16) * 1.6)(B, H, Sk, Dh)),
            "wq": _w((lambda *s: torch.randn(*s, dtype=torch.bfloat16) * 1.6)(D, H * Dh) * (D ** -0.5)),
            "wo": _w((lambda *s: torch.randn(*s, dtype=torch.bfloat16) * 1.6)(H * Dh, D) * ((H * Dh) ** -0.5)),
        }
    _A_in = _A_setup()

    def _B_setup():
        B, S, D, F = 1, 1, 640, 1728
        return {
            "x": _w((lambda *s: torch.randn(*s, dtype=torch.bfloat16) * 0.1)(B, S, D)),
            "w1": _w((lambda *s: torch.randn(*s, dtype=torch.bfloat16) * 3.2)(D, F) * (D ** -0.5)),
            "b1": _w((lambda *s: torch.randn(*s, dtype=torch.bfloat16) * 3.2)(F) * 0.01),
            "w2": _w((lambda *s: torch.randn(*s, dtype=torch.bfloat16) * 3.2)(F, D) * (F ** -0.5)),
            "b2": _w((lambda *s: torch.randn(*s, dtype=torch.bfloat16) * 3.2)(D) * 0.01),
        }
    _B_in = _B_setup()

    return {
        "A_x": _A_in["x"],
        "A_k_cache": _A_in["k_cache"],
        "A_v_cache": _A_in["v_cache"],
        "A_wq": _A_in["wq"],
        "A_wo": _A_in["wo"],
        "B_x": _B_in["x"],
        "B_w1": _B_in["w1"],
        "B_b1": _B_in["b1"],
        "B_w2": _B_in["w2"],
        "B_b2": _B_in["b2"],
    }

def reference(A_x, A_k_cache, A_v_cache, A_wq, A_wo, B_x, B_w1, B_b1, B_w2, B_b2):
    def _A_ref(x, k_cache, v_cache, wq, wo):
        B, Sq, D = x.shape
        H, Dh = 32, 128
        q = (lambda x, *d: x.permute(*d))((x @ wq).reshape(B, Sq, H, Dh), 0, 2, 1, 3)
        scores = torch.einsum("bhqd,bhkd->bhqk", q, k_cache) * (Dh ** -0.5)
        p = _softmax(scores, axis=-1)
        o = torch.einsum("bhqk,bhkd->bhqd", p, v_cache)
        return (lambda x, *d: x.permute(*d))(o, 0, 2, 1, 3).reshape(B, Sq, H * Dh) @ wo

    def _B_ref(x, w1, b1, w2, b2):
        h = torch.einsum("bsd,df->bsf", x, w1) + b1
        h = _gelu(h)
        return torch.einsum("bsf,fd->bsd", h, w2) + b2

    x = A_x
    h = x + _A_ref(_layernorm(x, axis=-1), A_k_cache, A_v_cache, A_wq, A_wo)
    h2 = h + _B_ref(_layernorm(h, axis=-1), B_w1, B_b1, B_w2, B_b2)
    return h2
```

```asm
; @launch grid=(256,1,1) block=(320,1,1) lds=145408
.amdgcn_target "amdgcn-amd-amdhsa--gfx950"
.text
.globl sequential_preLN__mha_block_cached__dense_activation_gelu__decode_kernel
.p2align 8
.type sequential_preLN__mha_block_cached__dense_activation_gelu__decode_kernel,@function
sequential_preLN__mha_block_cached__dense_activation_gelu__decode_kernel:
s_cmp_ge_u32 s2, 256
s_cbranch_scc1 L_end
s_load_dwordx16 s[36:51], s[0:1], 0
s_load_dwordx8 s[28:35], s[0:1], 64
s_load_dwordx2 s[52:53], s[0:1], 96
v_lshrrev_b32 v1, 6, v0
v_and_b32 v0, 63, v0
v_readfirstlane_b32 s3, v1
v_lshlrev_b32 v1, 4, v0
s_lshr_b32 s4, s2, 3
s_and_b32 s5, s2, 7
s_mov_b32 s79, 0x10000
s_mul_i32 s78, s5, 4
s_add_u32 s78, s78, s4
s_and_b32 s78, s78, 31
s_mov_b64 s[76:77], -1
v_mov_b32 v2, 0
s_mov_b32 s6, 0
s_mov_b32 s7, s78
s_cmp_lt_u32 s78, 10
s_cbranch_scc1 L_role
s_sub_u32 s54, s78, 10
s_lshr_b32 s55, s54, 2
s_lshl_b32 s55, s55, 3
s_add_u32 s55, s55, s5
s_lshl_b32 s7, s55, 2
s_and_b32 s54, s54, 3
s_add_u32 s7, s7, s54
s_cmp_lt_u32 s55, 27
s_cselect_b32 s6, 1, 3
s_cmp_lt_u32 s78, 26
s_cbranch_scc1 L_role
s_sub_u32 s7, s78, 26
s_lshl_b32 s7, s7, 3
s_add_u32 s7, s7, s5
s_cmp_lt_u32 s7, 20
s_cselect_b32 s6, 2, 3
L_role:
v_mov_b32 v28, -1
v_mov_b32 v29, -1
v_mov_b32 v30, -1
v_mov_b32 v31, -1
v_mov_b32 v3, 0
ds_write_b128 v1, v[28:31] offset:256
ds_write_b64 v2, v[2:3] offset:1536
s_waitcnt lgkmcnt(0)
s_barrier
s_mov_b32 s16, s52
s_and_b32 s17, s53, 0xffff
s_mov_b32 s18, 2097152
s_mov_b32 s19, 0x20000
s_cmp_lg_u32 s3, 0
s_cbranch_scc1 L_worker
s_mov_b32 s20, s34
s_and_b32 s21, s35, 0xffff
s_mov_b32 s22, 256
s_mov_b32 s23, 0x20000
v_mov_b32 v7, 0
s_lshl_b32 s57, s2, 9
s_add_u32 s54, s57, 131072
s_lshl_b32 s55, s2, 3
s_add_u32 s55, s55, 262144
s_mov_b32 exec_hi, 0
buffer_store_dwordx4 v[28:31], v1, s[16:19], s57 offen sc1
buffer_store_dwordx4 v[28:31], v1, s[16:19], s54 offen sc1
s_mov_b64 exec, 1
buffer_store_dwordx2 v[28:29], v7, s[16:19], s55 offen sc1
s_mul_i32 s56, s4, 4352
s_add_u32 s56, s56, 589824
s_cmp_lg_u32 s5, 0
s_cbranch_scc1 L_c1
buffer_store_dword v7, v7, s[16:19], s56 offen sc1
L_c1:
s_cmp_lg_u32 s6, 0
s_cbranch_scc1 L_c2
s_mul_i32 s54, s5, 2560
s_lshl_b32 s55, s7, 8
s_add_u32 s54, s54, s55
s_add_u32 s54, s54, 786432
s_mov_b64 exec, -1
v_lshrrev_b32 v9, 4, v0
v_mul_u32_u24 v9, 20480, v9
v_add_u32 v9, v9, v1
buffer_store_dwordx4 v[28:31], v9, s[16:19], s54 offen sc1
s_add_u32 s54, s54, 82944
L_c2:
s_cmp_lg_u32 s6, 1
s_cbranch_scc1 L_c3
s_mul_i32 s54, s7, 2560
s_add_u32 s54, s54, 294912
s_mov_b64 exec, -1
buffer_store_dwordx4 v[28:31], v1, s[16:19], s54 offen sc1
buffer_store_dwordx4 v[28:31], v1, s[16:19], s54 offen offset:1024 sc1
s_mov_b32 exec_hi, 0
buffer_store_dwordx4 v[28:31], v1, s[16:19], s54 offen offset:2048 sc1
L_c3:
v_mov_b32 v8, 1
s_lshl_b32 s55, s4, 3
s_mov_b64 exec, 1
s_waitcnt vmcnt(0)
buffer_atomic_add v8, v7, s[20:23], s55 offen sc1
s_mov_b64 exec, 1
v_mov_b32 v32, 1
ds_add_rtn_u32 v32, v2, v32 offset:1540
s_waitcnt lgkmcnt(0)
v_readfirstlane_b32 s58, v32
s_cmp_lg_u32 s58, 4
s_cbranch_scc1 L_qps
s_mov_b32 exec_lo, -1
ds_read_b128 v[32:35], v1 offset:12288
ds_read_b128 v[36:39], v1 offset:12800
ds_read_b128 v[40:43], v1 offset:13312
ds_read_b128 v[44:47], v1 offset:13824
s_lshl_b32 s58, s2, 9
s_waitcnt lgkmcnt(0)
v_add_f32 v32, v32, v36
v_add_f32 v40, v40, v44
v_add_f32 v33, v33, v37
v_add_f32 v41, v41, v45
v_add_f32 v34, v34, v38
v_add_f32 v42, v42, v46
v_add_f32 v35, v35, v39
v_add_f32 v43, v43, v47
v_add_f32 v32, v32, v40
v_add_f32 v33, v33, v41
v_add_f32 v34, v34, v42
v_add_f32 v35, v35, v43
v_min_u32 v32, -2, v32
v_min_u32 v33, -2, v33
v_min_u32 v34, -2, v34
v_min_u32 v35, -2, v35
buffer_store_dwordx4 v[32:35], v1, s[16:19], s58 offen sc1
L_qps:
s_mov_b64 exec, 1
L_pf:
s_sub_u32 s79, s79, 1
s_cbranch_scc1 L_end
s_sleep 64
buffer_load_dword v8, v7, s[20:23], s55 offen sc1
s_waitcnt vmcnt(0)
v_readfirstlane_b32 s54, v8
s_cmp_lt_u32 s54, 8
s_cbranch_scc1 L_pf
s_lshl_b32 s54, s4, 12
s_and_b64 s[60:61], -1, s[76:77]
s_and_b64 s[62:63], -1, s[76:77]
s_and_b64 s[64:65], -1, s[76:77]
s_and_b64 s[66:67], -1, s[76:77]
G1_top:
s_sub_u32 s79, s79, 1
s_cbranch_scc1 L_end
s_mov_b64 exec, s[60:61]
s_cbranch_execz G1_s0
buffer_load_dwordx4 v[32:35], v1, s[16:19], s54 offen offset:0 sc1
G1_s0:
s_mov_b64 exec, s[62:63]
s_cbranch_execz G1_s1
buffer_load_dwordx4 v[36:39], v1, s[16:19], s54 offen offset:1024 sc1
G1_s1:
s_mov_b64 exec, s[64:65]
s_cbranch_execz G1_s2
buffer_load_dwordx4 v[40:43], v1, s[16:19], s54 offen offset:2048 sc1
G1_s2:
s_mov_b64 exec, s[66:67]
s_cbranch_execz G1_s3
buffer_load_dwordx4 v[44:47], v1, s[16:19], s54 offen offset:3072 sc1
G1_s3:
G1_d:
s_mov_b64 s[58:59], 0
s_waitcnt vmcnt(0)
s_mov_b64 exec, s[60:61]
v_max3_u32 v3, v32, v33, v34
v_max_u32 v3, v3, v35
v_cmp_eq_u32 s[60:61], -1, v3
s_or_b64 s[58:59], s[58:59], s[60:61]
s_mov_b64 exec, s[62:63]
v_max3_u32 v3, v36, v37, v38
v_max_u32 v3, v3, v39
v_cmp_eq_u32 s[62:63], -1, v3
s_or_b64 s[58:59], s[58:59], s[62:63]
s_mov_b64 exec, s[64:65]
v_max3_u32 v3, v40, v41, v42
v_max_u32 v3, v3, v43
v_cmp_eq_u32 s[64:65], -1, v3
s_or_b64 s[58:59], s[58:59], s[64:65]
s_mov_b64 exec, s[66:67]
v_max3_u32 v3, v44, v45, v46
v_max_u32 v3, v3, v47
v_cmp_eq_u32 s[66:67], -1, v3
s_or_b64 s[58:59], s[58:59], s[66:67]
s_cbranch_scc1 G1_top
s_and_b64 exec, -1, s[76:77]
v_add_f32 v32, v32, v36
v_add_f32 v40, v40, v44
v_add_f32 v33, v33, v37
v_add_f32 v41, v41, v45
v_add_f32 v34, v34, v38
v_add_f32 v42, v42, v46
v_add_f32 v35, v35, v39
v_add_f32 v43, v43, v47
v_add_f32 v32, v32, v40
v_add_f32 v33, v33, v41
v_add_f32 v34, v34, v42
v_add_f32 v35, v35, v43
s_nop 1
v_permlane32_swap_b32 v32, v34
v_permlane32_swap_b32 v33, v35
s_nop 1
v_add_f32 v32, v32, v34
v_add_f32 v33, v33, v35
v_cvt_pk_bf16_f32 v32, v32, v33
v_and_b32 v5, 31, v0
v_lshlrev_b32 v5, 3, v5
v_lshrrev_b32 v6, 5, v0
v_lshl_add_u32 v5, v6, 2, v5
ds_write_b32 v5, v32 offset:0
s_waitcnt lgkmcnt(0)
s_barrier
v_lshlrev_b32 v5, 3, v0
s_mov_b32 exec_hi, 0
L_pa:
s_sub_u32 s79, s79, 1
s_cbranch_scc1 L_end
s_sleep 16
buffer_load_dword v8, v5, s[20:23], 0 offen sc1
s_waitcnt vmcnt(0)
v_cmp_gt_u32 vcc, 8, v8
s_nop 4
s_cbranch_vccnz L_pa
s_mov_b64 exec, -1
v_mov_b32 v6, 0
v_mov_b32 v37, 0
v_mov_b32 v3, 0
v_mov_b32 v38, 0
v_mov_b32 v39, 0
s_mov_b32 s96, s56
s_mov_b64 s[76:77], 0
s_mov_b64 exec, 0
s_branch L_dry
L_dryret:
s_mov_b32 s56, s96
s_mov_b64 exec, -1
v_lshlrev_b32 v11, 14, v0
v_lshlrev_b32 v12, 2, v0
s_mov_b32 s64, 1044133936
s_mov_b32 s65, 16447
s_mov_b32 s63, 0
s_mov_b64 exec, 1
s_mov_b32 s54, 1
v_mov_b32 v9, 0
L_tk:
s_sub_u32 s79, s79, 1
s_cbranch_scc1 L_end
ds_read_b32 v8, v7 offset:1536
s_waitcnt lgkmcnt(0)
v_readfirstlane_b32 s55, v8
s_cmp_ge_u32 s55, s54
s_cbranch_scc1 L_tk2
s_sleep 2
s_branch L_tk
L_tk2:
v_mov_b32 v8, 1
buffer_atomic_add v8, v7, s[16:19], s56 offen sc0 sc1
s_waitcnt vmcnt(0)
v_readfirstlane_b32 s55, v8
s_min_u32 s55, s55, 40
s_andn2_b32 s58, s55, 7
s_lshr_b64 s[60:61], s[64:65], s58
s_and_b32 s59, s60, 0xff
s_bfe_u32 s62, s60, 0x80008
s_sub_u32 s62, s62, s59
s_and_b32 s57, s55, 7
s_lshl_b32 s57, s57, 6
s_add_u32 s57, s57, s59
s_lshl_b32 s57, s57, 14
s_cmp_lt_u32 s55, 40
s_cselect_b32 s57, s57, 8388608
s_cselect_b32 s62, s62, 1
s_bfm_b64 exec, s62, 0
v_add_u32 v8, s57, v11
v_add_u32 v9, s63, v12
ds_write_b32 v9, v8 offset:256
s_mov_b64 exec, 1
s_add_u32 s54, s54, s62
s_lshl2_add_u32 s63, s62, s63
s_cmp_lt_u32 s55, 40
s_cbranch_scc1 L_tk
s_waitcnt lgkmcnt(0)
s_endpgm
L_worker:
s_sub_u32 s3, s3, 1
s_lshl_b32 s54, s4, 23
s_add_u32 s8, s38, s54
s_addc_u32 s9, s39, 0
s_and_b32 s9, s9, 0xffff
s_mov_b32 s10, 8388608
s_mov_b32 s11, 0x20000
s_add_u32 s12, s40, s54
s_addc_u32 s13, s41, 0
s_and_b32 s13, s13, 0xffff
s_mov_b32 s14, 8388608
s_mov_b32 s15, 0x20000
s_lshl_b32 s56, s3, 12
s_mul_i32 s57, s5, 1048576
s_add_u32 s57, s57, s56
s_mov_b32 s20, s42
s_and_b32 s21, s43, 0xffff
s_mov_b32 s22, 5242880
s_mov_b32 s23, 0x20000
s_mov_b32 s24, s36
s_and_b32 s25, s37, 0xffff
s_mov_b32 s26, 1280
s_mov_b32 s27, 0x20000
v_lshrrev_b32 v4, 4, v0
v_and_b32 v3, 15, v0
v_mul_u32_u24 v5, 40960, v4
v_lshl_add_u32 v5, v3, 4, v5
s_lshl_b32 s54, s5, 2
s_add_u32 s54, s54, s3
s_mul_i32 s55, s54, 40
s_mul_i32 s54, s54, 163840
s_lshl_b32 s58, s4, 8
s_add_u32 s54, s54, s58
v_lshlrev_b32 v6, 2, v0
v_mul_u32_u24 v7, 10, v4
buffer_load_dword v168, v6, s[24:27], 0 offen offset:0
buffer_load_dword v169, v6, s[24:27], 0 offen offset:256
buffer_load_dword v170, v6, s[24:27], 0 offen offset:512
buffer_load_dword v171, v6, s[24:27], 0 offen offset:768
buffer_load_dword v172, v6, s[24:27], 0 offen offset:1024
buffer_load_short_d16_hi v176, v7, s[24:27], s55 offen offset:0
buffer_load_short_d16_hi v177, v7, s[24:27], s55 offen offset:2
buffer_load_short_d16_hi v178, v7, s[24:27], s55 offen offset:4
buffer_load_short_d16_hi v179, v7, s[24:27], s55 offen offset:6
buffer_load_short_d16_hi v180, v7, s[24:27], s55 offen offset:8
buffer_load_dwordx4 v[184:187], v5, s[20:23], s54 offen nt
s_add_u32 s54, s54, 8192
buffer_load_dwordx4 v[188:191], v5, s[20:23], s54 offen nt
s_add_u32 s54, s54, 8192
buffer_load_dwordx4 v[192:195], v5, s[20:23], s54 offen nt
s_add_u32 s54, s54, 8192
buffer_load_dwordx4 v[196:199], v5, s[20:23], s54 offen nt
s_add_u32 s54, s54, 8192
buffer_load_dwordx4 v[200:203], v5, s[20:23], s54 offen nt
s_add_u32 s54, s54, 8192
buffer_load_dwordx4 v[40:43], v1, s[8:11], s57 offen offset:0 nt
buffer_load_dwordx4 v[44:47], v1, s[8:11], s57 offen offset:1024 nt
buffer_load_dwordx4 v[48:51], v1, s[8:11], s57 offen offset:2048 nt
buffer_load_dwordx4 v[52:55], v1, s[8:11], s57 offen offset:3072 nt
buffer_load_dwordx4 v[56:59], v1, s[12:15], s57 offen offset:0 nt
buffer_load_dwordx4 v[60:63], v1, s[12:15], s57 offen offset:1024 nt
buffer_load_dwordx4 v[64:67], v1, s[12:15], s57 offen offset:2048 nt
buffer_load_dwordx4 v[68:71], v1, s[12:15], s57 offen offset:3072 nt
s_add_u32 s57, s57, 16384
buffer_load_dwordx4 v[72:75], v1, s[8:11], s57 offen offset:0 nt
buffer_load_dwordx4 v[76:79], v1, s[8:11], s57 offen offset:1024 nt
buffer_load_dwordx4 v[80:83], v1, s[8:11], s57 offen offset:2048 nt
buffer_load_dwordx4 v[84:87], v1, s[8:11], s57 offen offset:3072 nt
s_waitcnt vmcnt(17)
buffer_load_dwordx4 v[88:91], v1, s[12:15], s57 offen offset:0 nt
buffer_load_dwordx4 v[92:95], v1, s[12:15], s57 offen offset:1024 nt
buffer_load_dwordx4 v[96:99], v1, s[12:15], s57 offen offset:2048 nt
buffer_load_dwordx4 v[100:103], v1, s[12:15], s57 offen offset:3072 nt
s_add_u32 s57, s57, 16384
v_lshlrev_b32 v208, 16, v168
v_and_b32 v209, 0xffff0000, v168
v_lshlrev_b32 v210, 16, v169
v_and_b32 v211, 0xffff0000, v169
v_lshlrev_b32 v212, 16, v170
v_and_b32 v213, 0xffff0000, v170
v_lshlrev_b32 v214, 16, v171
v_and_b32 v215, 0xffff0000, v171
v_lshlrev_b32 v216, 16, v172
v_and_b32 v217, 0xffff0000, v172
v_add_f32 v18, v208, v209
v_add_f32 v18, v18, v210
v_add_f32 v18, v18, v211
v_add_f32 v18, v18, v212
v_add_f32 v18, v18, v213
v_add_f32 v18, v18, v214
v_add_f32 v18, v18, v215
v_add_f32 v18, v18, v216
v_add_f32 v18, v18, v217
s_nop 1
v_add_f32_dpp v18, v18, v18 row_ror:8 row_mask:0xf bank_mask:0xf
s_nop 1
v_add_f32_dpp v18, v18, v18 row_ror:4 row_mask:0xf bank_mask:0xf
s_nop 1
v_add_f32_dpp v18, v18, v18 row_ror:2 row_mask:0xf bank_mask:0xf
s_nop 1
v_add_f32_dpp v18, v18, v18 row_ror:1 row_mask:0xf bank_mask:0xf
v_mov_b32 v20, v18
s_nop 1
v_permlane16_swap_b32 v18, v20
s_nop 1
v_add_f32 v18, v18, v20
v_mov_b32 v20, v18
s_nop 1
v_permlane32_swap_b32 v18, v20
s_nop 1
v_add_f32 v18, v18, v20
v_mul_f32 v18, 0x3acccccd, v18
v_sub_f32 v20, v208, v18
v_mul_f32 v19, v20, v20
v_sub_f32 v20, v209, v18
v_fmac_f32 v19, v20, v20
v_sub_f32 v20, v210, v18
v_fmac_f32 v19, v20, v20
v_sub_f32 v20, v211, v18
v_fmac_f32 v19, v20, v20
v_sub_f32 v20, v212, v18
v_fmac_f32 v19, v20, v20
v_sub_f32 v20, v213, v18
v_fmac_f32 v19, v20, v20
v_sub_f32 v20, v214, v18
v_fmac_f32 v19, v20, v20
v_sub_f32 v20, v215, v18
v_fmac_f32 v19, v20, v20
v_sub_f32 v20, v216, v18
v_fmac_f32 v19, v20, v20
v_sub_f32 v20, v217, v18
v_fmac_f32 v19, v20, v20
s_nop 1
v_add_f32_dpp v19, v19, v19 row_ror:8 row_mask:0xf bank_mask:0xf
s_nop 1
v_add_f32_dpp v19, v19, v19 row_ror:4 row_mask:0xf bank_mask:0xf
s_nop 1
v_add_f32_dpp v19, v19, v19 row_ror:2 row_mask:0xf bank_mask:0xf
s_nop 1
v_add_f32_dpp v19, v19, v19 row_ror:1 row_mask:0xf bank_mask:0xf
v_mov_b32 v20, v19
s_nop 1
v_permlane16_swap_b32 v19, v20
s_nop 1
v_add_f32 v19, v19, v20
v_mov_b32 v20, v19
s_nop 1
v_permlane32_swap_b32 v19, v20
s_nop 1
v_add_f32 v19, v19, v20
v_mul_f32 v19, 0x3acccccd, v19
v_cvt_pk_bf16_f32 v19, v19, v19
v_and_b32 v19, 0xffff0000, v19
v_add_f32 v19, 0x3727c5ac, v19
v_cvt_pk_bf16_f32 v19, v19, v19
v_and_b32 v19, 0xffff0000, v19
v_sqrt_f32 v19, v19
s_nop 0
v_cvt_pk_bf16_f32 v19, v19, v19
v_and_b32 v19, 0xffff0000, v19
v_rcp_f32 v19, v19
v_cvt_pk_bf16_f32 v18, v18, v18
v_and_b32 v18, 0xffff0000, v18
v_and_b32 v176, 0xffff0000, v176
v_sub_f32 v176, v176, v18
v_cvt_pk_bf16_f32 v176, v176, v176
v_and_b32 v176, 0xffff0000, v176
v_mul_f32 v176, v176, v19
v_cvt_pk_bf16_f32 v176, v176, v176
v_and_b32 v176, 0xffff0000, v176
v_and_b32 v177, 0xffff0000, v177
v_sub_f32 v177, v177, v18
v_cvt_pk_bf16_f32 v177, v177, v177
v_and_b32 v177, 0xffff0000, v177
v_mul_f32 v177, v177, v19
v_cvt_pk_bf16_f32 v177, v177, v177
v_and_b32 v177, 0xffff0000, v177
v_and_b32 v178, 0xffff0000, v178
v_sub_f32 v178, v178, v18
v_cvt_pk_bf16_f32 v178, v178, v178
v_and_b32 v178, 0xffff0000, v178
v_mul_f32 v178, v178, v19
v_cvt_pk_bf16_f32 v178, v178, v178
v_and_b32 v178, 0xffff0000, v178
v_and_b32 v179, 0xffff0000, v179
v_sub_f32 v179, v179, v18
v_cvt_pk_bf16_f32 v179, v179, v179
v_and_b32 v179, 0xffff0000, v179
v_mul_f32 v179, v179, v19
v_cvt_pk_bf16_f32 v179, v179, v179
v_and_b32 v179, 0xffff0000, v179
v_and_b32 v180, 0xffff0000, v180
v_sub_f32 v180, v180, v18
v_cvt_pk_bf16_f32 v180, v180, v180
v_and_b32 v180, 0xffff0000, v180
v_mul_f32 v180, v180, v19
v_cvt_pk_bf16_f32 v180, v180, v180
v_and_b32 v180, 0xffff0000, v180
v_mov_b32 v8, 0
v_mov_b32 v9, 0
v_mov_b32 v10, 0
v_mov_b32 v11, 0
v_mov_b32 v12, 0
v_mov_b32 v13, 0
v_mov_b32 v14, 0
v_mov_b32 v15, 0
s_waitcnt vmcnt(20)
v_lshlrev_b32 v24, 16, v184
v_and_b32 v25, 0xffff0000, v184
v_lshlrev_b32 v26, 16, v185
v_and_b32 v27, 0xffff0000, v185
v_lshlrev_b32 v28, 16, v186
v_and_b32 v29, 0xffff0000, v186
v_lshlrev_b32 v30, 16, v187
v_and_b32 v31, 0xffff0000, v187
v_pk_fma_f32 v[8:9], v[24:25], v[176:177], v[8:9] op_sel:[0,0,0] op_sel_hi:[1,0,1]
v_pk_fma_f32 v[10:11], v[26:27], v[176:177], v[10:11] op_sel:[0,0,0] op_sel_hi:[1,0,1]
v_pk_fma_f32 v[12:13], v[28:29], v[176:177], v[12:13] op_sel:[0,0,0] op_sel_hi:[1,0,1]
v_pk_fma_f32 v[14:15], v[30:31], v[176:177], v[14:15] op_sel:[0,0,0] op_sel_hi:[1,0,1]
s_waitcnt vmcnt(19)
v_lshlrev_b32 v24, 16, v188
v_and_b32 v25, 0xffff0000, v188
v_lshlrev_b32 v26, 16, v189
v_and_b32 v27, 0xffff0000, v189
v_lshlrev_b32 v28, 16, v190
v_and_b32 v29, 0xffff0000, v190
v_lshlrev_b32 v30, 16, v191
v_and_b32 v31, 0xffff0000, v191
v_pk_fma_f32 v[8:9], v[24:25], v[176:177], v[8:9] op_sel:[0,1,0] op_sel_hi:[1,1,1]
v_pk_fma_f32 v[10:11], v[26:27], v[176:177], v[10:11] op_sel:[0,1,0] op_sel_hi:[1,1,1]
v_pk_fma_f32 v[12:13], v[28:29], v[176:177], v[12:13] op_sel:[0,1,0] op_sel_hi:[1,1,1]
v_pk_fma_f32 v[14:15], v[30:31], v[176:177], v[14:15] op_sel:[0,1,0] op_sel_hi:[1,1,1]
s_waitcnt vmcnt(18)
v_lshlrev_b32 v24, 16, v192
v_and_b32 v25, 0xffff0000, v192
v_lshlrev_b32 v26, 16, v193
v_and_b32 v27, 0xffff0000, v193
v_lshlrev_b32 v28, 16, v194
v_and_b32 v29, 0xffff0000, v194
v_lshlrev_b32 v30, 16, v195
v_and_b32 v31, 0xffff0000, v195
v_pk_fma_f32 v[8:9], v[24:25], v[178:179], v[8:9] op_sel:[0,0,0] op_sel_hi:[1,0,1]
v_pk_fma_f32 v[10:11], v[26:27], v[178:179], v[10:11] op_sel:[0,0,0] op_sel_hi:[1,0,1]
v_pk_fma_f32 v[12:13], v[28:29], v[178:179], v[12:13] op_sel:[0,0,0] op_sel_hi:[1,0,1]
v_pk_fma_f32 v[14:15], v[30:31], v[178:179], v[14:15] op_sel:[0,0,0] op_sel_hi:[1,0,1]
s_waitcnt vmcnt(17)
v_lshlrev_b32 v24, 16, v196
v_and_b32 v25, 0xffff0000, v196
v_lshlrev_b32 v26, 16, v197
v_and_b32 v27, 0xffff0000, v197
v_lshlrev_b32 v28, 16, v198
v_and_b32 v29, 0xffff0000, v198
v_lshlrev_b32 v30, 16, v199
v_and_b32 v31, 0xffff0000, v199
v_pk_fma_f32 v[8:9], v[24:25], v[178:179], v[8:9] op_sel:[0,1,0] op_sel_hi:[1,1,1]
v_pk_fma_f32 v[10:11], v[26:27], v[178:179], v[10:11] op_sel:[0,1,0] op_sel_hi:[1,1,1]
v_pk_fma_f32 v[12:13], v[28:29], v[178:179], v[12:13] op_sel:[0,1,0] op_sel_hi:[1,1,1]
v_pk_fma_f32 v[14:15], v[30:31], v[178:179], v[14:15] op_sel:[0,1,0] op_sel_hi:[1,1,1]
s_waitcnt vmcnt(16)
v_lshlrev_b32 v24, 16, v200
v_and_b32 v25, 0xffff0000, v200
v_lshlrev_b32 v26, 16, v201
v_and_b32 v27, 0xffff0000, v201
v_lshlrev_b32 v28, 16, v202
v_and_b32 v29, 0xffff0000, v202
v_lshlrev_b32 v30, 16, v203
v_and_b32 v31, 0xffff0000, v203
v_pk_fma_f32 v[8:9], v[24:25], v[180:181], v[8:9] op_sel:[0,0,0] op_sel_hi:[1,0,1]
v_pk_fma_f32 v[10:11], v[26:27], v[180:181], v[10:11] op_sel:[0,0,0] op_sel_hi:[1,0,1]
v_pk_fma_f32 v[12:13], v[28:29], v[180:181], v[12:13] op_sel:[0,0,0] op_sel_hi:[1,0,1]
v_pk_fma_f32 v[14:15], v[30:31], v[180:181], v[14:15] op_sel:[0,0,0] op_sel_hi:[1,0,1]
s_nop 1
v_permlane32_swap_b32 v8, v12
v_permlane32_swap_b32 v9, v13
v_permlane32_swap_b32 v10, v14
v_permlane32_swap_b32 v11, v15
s_nop 1
v_add_f32 v8, v8, v12
v_add_f32 v9, v9, v13
v_add_f32 v10, v10, v14
v_add_f32 v11, v11, v15
s_nop 1
v_permlane16_swap_b32 v8, v10
v_permlane16_swap_b32 v9, v11
s_nop 1
v_add_f32 v8, v8, v10
v_add_f32 v9, v9, v11
v_lshlrev_b32 v3, 5, v3
v_lshl_add_u32 v3, v4, 3, v3
s_lshl_b32 s54, s3, 9
v_add_u32 v3, s54, v3
ds_write_b64 v3, v[8:9] offset:12288
s_waitcnt lgkmcnt(0)
s_mov_b64 exec, 1
v_mov_b32 v168, 1
ds_add_rtn_u32 v168, v2, v168 offset:1540
s_waitcnt lgkmcnt(0)
v_readfirstlane_b32 s58, v168
s_cmp_lg_u32 s58, 4
s_cbranch_scc1 L_qpw
s_mov_b32 exec_lo, -1
ds_read_b128 v[168:171], v1 offset:12288
ds_read_b128 v[172:175], v1 offset:12800
ds_read_b128 v[176:179], v1 offset:13312
ds_read_b128 v[180:183], v1 offset:13824
s_lshl_b32 s58, s2, 9
s_waitcnt lgkmcnt(0)
v_add_f32 v168, v168, v172
v_add_f32 v176, v176, v180
v_add_f32 v169, v169, v173
v_add_f32 v177, v177, v181
v_add_f32 v170, v170, v174
v_add_f32 v178, v178, v182
v_add_f32 v171, v171, v175
v_add_f32 v179, v179, v183
v_add_f32 v168, v168, v176
v_add_f32 v169, v169, v177
v_add_f32 v170, v170, v178
v_add_f32 v171, v171, v179
v_min_u32 v168, -2, v168
v_min_u32 v169, -2, v169
v_min_u32 v170, -2, v170
v_min_u32 v171, -2, v171
buffer_store_dwordx4 v[168:171], v1, s[16:19], s58 offen sc1
L_qpw:
s_mov_b64 exec, -1
s_waitcnt vmcnt(4)
buffer_load_dwordx4 v[104:107], v1, s[8:11], s57 offen offset:0 nt
buffer_load_dwordx4 v[108:111], v1, s[8:11], s57 offen offset:1024 nt
buffer_load_dwordx4 v[112:115], v1, s[8:11], s57 offen offset:2048 nt
buffer_load_dwordx4 v[116:119], v1, s[8:11], s57 offen offset:3072 nt
s_waitcnt vmcnt(4)
buffer_load_dwordx4 v[120:123], v1, s[12:15], s57 offen offset:0 nt
buffer_load_dwordx4 v[124:127], v1, s[12:15], s57 offen offset:1024 nt
buffer_load_dwordx4 v[128:131], v1, s[12:15], s57 offen offset:2048 nt
buffer_load_dwordx4 v[132:135], v1, s[12:15], s57 offen offset:3072 nt
s_add_u32 s57, s57, 16384
s_waitcnt vmcnt(4)
buffer_load_dwordx4 v[136:139], v1, s[8:11], s57 offen offset:0 nt
buffer_load_dwordx4 v[140:143], v1, s[8:11], s57 offen offset:1024 nt
buffer_load_dwordx4 v[144:147], v1, s[8:11], s57 offen offset:2048 nt
buffer_load_dwordx4 v[148:151], v1, s[8:11], s57 offen offset:3072 nt
s_waitcnt vmcnt(4)
buffer_load_dwordx4 v[152:155], v1, s[12:15], s57 offen offset:0 nt
buffer_load_dwordx4 v[156:159], v1, s[12:15], s57 offen offset:1024 nt
buffer_load_dwordx4 v[160:163], v1, s[12:15], s57 offen offset:2048 nt
buffer_load_dwordx4 v[164:167], v1, s[12:15], s57 offen offset:3072 nt
s_add_u32 s57, s57, 16384
s_lshl_b32 s54, s3, 13
s_add_u32 m0, s54, 14336
s_waitcnt vmcnt(4)
buffer_load_dwordx4 v1, s[8:11], s57 offen offset:0 nt lds
buffer_load_dwordx4 v1, s[8:11], s57 offen offset:1024 nt lds
buffer_load_dwordx4 v1, s[8:11], s57 offen offset:2048 nt lds
buffer_load_dwordx4 v1, s[8:11], s57 offen offset:3072 nt lds
s_lshl_b32 s54, s3, 13
s_add_u32 m0, s54, 18432
s_waitcnt vmcnt(4)
buffer_load_dwordx4 v1, s[12:15], s57 offen offset:0 nt lds
buffer_load_dwordx4 v1, s[12:15], s57 offen offset:1024 nt lds
buffer_load_dwordx4 v1, s[12:15], s57 offen offset:2048 nt lds
buffer_load_dwordx4 v1, s[12:15], s57 offen offset:3072 nt lds
s_add_u32 s57, s57, 16384
s_lshl_b32 s54, s3, 13
s_add_u32 m0, s54, 47104
s_waitcnt vmcnt(4)
buffer_load_dwordx4 v1, s[8:11], s57 offen offset:0 nt lds
buffer_load_dwordx4 v1, s[8:11], s57 offen offset:1024 nt lds
buffer_load_dwordx4 v1, s[8:11], s57 offen offset:2048 nt lds
buffer_load_dwordx4 v1, s[8:11], s57 offen offset:3072 nt lds
s_lshl_b32 s54, s3, 13
s_add_u32 m0, s54, 51200
s_waitcnt vmcnt(4)
buffer_load_dwordx4 v1, s[12:15], s57 offen offset:0 nt lds
buffer_load_dwordx4 v1, s[12:15], s57 offen offset:1024 nt lds
buffer_load_dwordx4 v1, s[12:15], s57 offen offset:2048 nt lds
buffer_load_dwordx4 v1, s[12:15], s57 offen offset:3072 nt lds
s_add_u32 s57, s57, 16384
s_lshl_b32 s54, s3, 13
s_add_u32 m0, s54, 79872
s_waitcnt vmcnt(4)
buffer_load_dwordx4 v1, s[8:11], s57 offen offset:0 nt lds
buffer_load_dwordx4 v1, s[8:11], s57 offen offset:1024 nt lds
buffer_load_dwordx4 v1, s[8:11], s57 offen offset:2048 nt lds
buffer_load_dwordx4 v1, s[8:11], s57 offen offset:3072 nt lds
s_lshl_b32 s54, s3, 13
s_add_u32 m0, s54, 83968
s_waitcnt vmcnt(4)
buffer_load_dwordx4 v1, s[12:15], s57 offen offset:0 nt lds
buffer_load_dwordx4 v1, s[12:15], s57 offen offset:1024 nt lds
buffer_load_dwordx4 v1, s[12:15], s57 offen offset:2048 nt lds
buffer_load_dwordx4 v1, s[12:15], s57 offen offset:3072 nt lds
s_add_u32 s57, s57, 16384
s_lshl_b32 s54, s3, 13
s_add_u32 m0, s54, 112640
s_waitcnt vmcnt(4)
buffer_load_dwordx4 v1, s[8:11], s57 offen offset:0 nt lds
buffer_load_dwordx4 v1, s[8:11], s57 offen offset:1024 nt lds
buffer_load_dwordx4 v1, s[8:11], s57 offen offset:2048 nt lds
buffer_load_dwordx4 v1, s[8:11], s57 offen offset:3072 nt lds
s_lshl_b32 s54, s3, 13
s_add_u32 m0, s54, 116736
s_waitcnt vmcnt(4)
buffer_load_dwordx4 v1, s[12:15], s57 offen offset:0 nt lds
buffer_load_dwordx4 v1, s[12:15], s57 offen offset:1024 nt lds
buffer_load_dwordx4 v1, s[12:15], s57 offen offset:2048 nt lds
buffer_load_dwordx4 v1, s[12:15], s57 offen offset:3072 nt lds
s_add_u32 s57, s57, 16384
s_waitcnt vmcnt(4)
s_cmp_lg_u32 s6, 0
s_cbranch_scc1 L_w1
s_mov_b32 s20, s44
s_and_b32 s21, s45, 0xffff
s_mov_b32 s22, 5242880
s_mov_b32 s23, 0x20000
v_lshrrev_b32 v3, 3, v0
v_mul_u32_u24 v3, 20480, v3
v_and_b32 v38, 7, v0
v_lshl_add_u32 v3, v38, 4, v3
s_lshl_b32 s54, s5, 2
s_add_u32 s54, s54, s3
s_mul_i32 s54, s54, 163840
s_lshl_b32 s55, s7, 7
s_add_u32 s54, s54, s55
buffer_load_dwordx4 v[168:171], v3, s[20:23], s54 offen offset:0 nt
buffer_load_dwordx4 v[172:175], v3, s[20:23], s54 offen offset:1280 nt
buffer_load_dwordx4 v[176:179], v3, s[20:23], s54 offen offset:2560 nt
s_add_u32 s54, s54, 3840
buffer_load_dwordx4 v[180:183], v3, s[20:23], s54 offen offset:0 nt
buffer_load_dwordx4 v[184:187], v3, s[20:23], s54 offen offset:1280 nt
buffer_load_dwordx4 v[188:191], v3, s[20:23], s54 offen offset:2560 nt
s_add_u32 s54, s54, 3840
buffer_load_dwordx4 v[192:195], v3, s[20:23], s54 offen offset:0 nt
buffer_load_dwordx4 v[196:199], v3, s[20:23], s54 offen offset:1280 nt
buffer_load_dwordx4 v[200:203], v3, s[20:23], s54 offen offset:2560 nt
s_add_u32 s54, s54, 3840
buffer_load_dwordx4 v[204:207], v3, s[20:23], s54 offen offset:0 nt
buffer_load_dwordx4 v[208:211], v3, s[20:23], s54 offen offset:1280 nt
buffer_load_dwordx4 v[212:215], v3, s[20:23], s54 offen offset:2560 nt
s_add_u32 s54, s54, 3840
buffer_load_dwordx4 v[216:219], v3, s[20:23], s54 offen offset:0 nt
buffer_load_dwordx4 v[220:223], v3, s[20:23], s54 offen offset:1280 nt
buffer_load_dwordx4 v[224:227], v3, s[20:23], s54 offen offset:2560 nt
s_add_u32 s54, s54, 3840
buffer_load_dwordx4 v[228:231], v3, s[20:23], s54 offen offset:0 nt
s_branch L_w3
L_w1:
s_cmp_lg_u32 s6, 1
s_cbranch_scc1 L_w2
s_mov_b32 s20, s48
s_and_b32 s21, s49, 0xffff
s_mov_b32 s22, 2211840
s_mov_b32 s23, 0x20000
v_lshrrev_b32 v3, 1, v0
v_mul_u32_u24 v3, 17280, v3
v_and_b32 v38, 1, v0
v_lshl_add_u32 v3, v38, 4, v3
s_mul_i32 s54, s3, 552960
s_lshl_b32 s55, s7, 5
s_add_u32 s54, s54, s55
buffer_load_dwordx4 v[168:171], v3, s[20:23], s54 offen
s_add_u32 s54, s54, 3456
buffer_load_dwordx4 v[172:175], v3, s[20:23], s54 offen
s_add_u32 s54, s54, 3456
buffer_load_dwordx4 v[176:179], v3, s[20:23], s54 offen
s_add_u32 s54, s54, 3456
buffer_load_dwordx4 v[180:183], v3, s[20:23], s54 offen
s_add_u32 s54, s54, 3456
buffer_load_dwordx4 v[184:187], v3, s[20:23], s54 offen
s_add_u32 s54, s54, 3456
s_mov_b32 s20, s50
s_and_b32 s21, s51, 0xffff
s_mov_b32 s22, 3456
s_mov_b32 s23, 0x20000
v_and_b32 v3, 15, v0
v_lshlrev_b32 v3, 1, v3
buffer_load_ushort v188, v3, s[20:23], s55 offen
s_mov_b32 s20, s28
s_and_b32 s21, s29, 0xffff
s_mov_b32 s22, 2211840
s_mov_b32 s23, 0x20000
v_lshlrev_b32 v3, 3, v0
s_mul_i32 s54, s7, 20480
s_mul_i32 s55, s3, 320
s_add_u32 s54, s54, s55
s_mov_b32 exec_hi, 0xff
buffer_load_dwordx2 v[192:193], v3, s[20:23], s54 offen offset:0 nt
buffer_load_dwordx2 v[194:195], v3, s[20:23], s54 offen offset:1280 nt
buffer_load_dwordx2 v[196:197], v3, s[20:23], s54 offen offset:2560 nt
s_add_u32 s54, s54, 3840
buffer_load_dwordx2 v[198:199], v3, s[20:23], s54 offen offset:0 nt
buffer_load_dwordx2 v[200:201], v3, s[20:23], s54 offen offset:1280 nt
buffer_load_dwordx2 v[202:203], v3, s[20:23], s54 offen offset:2560 nt
s_add_u32 s54, s54, 3840
buffer_load_dwordx2 v[204:205], v3, s[20:23], s54 offen offset:0 nt
buffer_load_dwordx2 v[206:207], v3, s[20:23], s54 offen offset:1280 nt
buffer_load_dwordx2 v[208:209], v3, s[20:23], s54 offen offset:2560 nt
s_add_u32 s54, s54, 3840
buffer_load_dwordx2 v[210:211], v3, s[20:23], s54 offen offset:0 nt
buffer_load_dwordx2 v[212:213], v3, s[20:23], s54 offen offset:1280 nt
buffer_load_dwordx2 v[214:215], v3, s[20:23], s54 offen offset:2560 nt
s_add_u32 s54, s54, 3840
buffer_load_dwordx2 v[216:217], v3, s[20:23], s54 offen offset:0 nt
buffer_load_dwordx2 v[218:219], v3, s[20:23], s54 offen offset:1280 nt
buffer_load_dwordx2 v[220:221], v3, s[20:23], s54 offen offset:2560 nt
s_add_u32 s54, s54, 3840
buffer_load_dwordx2 v[222:223], v3, s[20:23], s54 offen offset:0 nt
s_mov_b32 s20, s36
s_and_b32 s21, s37, 0xffff
s_mov_b32 s22, 1280
s_mov_b32 s23, 0x20000
buffer_load_dwordx2 v[190:191], v3, s[20:23], s55 offen
s_mov_b64 exec, -1
s_branch L_w3
L_w2:
s_cmp_lg_u32 s6, 2
s_cbranch_scc1 L_w3
v_and_b32 v3, 1, v0
v_lshlrev_b32 v3, 3, v3
s_lshl_b32 s54, s7, 2
s_add_u32 s54, s54, s3
s_lshl_b32 s54, s54, 4
s_mov_b32 s20, s36
s_and_b32 s21, s37, 0xffff
s_mov_b32 s22, 1280
s_mov_b32 s23, 0x20000
buffer_load_dwordx2 v[168:169], v3, s[20:23], s54 offen
s_mov_b32 s20, s30
s_and_b32 s21, s31, 0xffff
s_mov_b32 s22, 1280
s_mov_b32 s23, 0x20000
buffer_load_dwordx2 v[170:171], v3, s[20:23], s54 offen
L_w3:
v_mov_b32 v8, 0
v_mov_b32 v9, 0
v_mov_b32 v10, 0
v_mov_b32 v11, 0
v_mov_b32 v12, 0
v_mov_b32 v13, 0
v_mov_b32 v14, 0
v_mov_b32 v15, 0
v_mov_b32 v16, 0xff7fffff
v_mov_b32 v17, 0
v_mov_b32 v2, 0
v_mov_b32 v36, 0
v_mov_b32 v37, 1
s_mov_b32 s24, 0x3fb8aa3b
s_mov_b32 s25, 0xffff0000
v_and_b32 v3, 0xf0, v1
s_barrier
ds_read_b128 v[4:7], v3 offset:0
s_waitcnt lgkmcnt(0)
s_lshl_b32 s54, s3, 13
v_add_u32 v39, s54, v1
v_add_u32 v39, 14336, v39
v_dot2_f32_bf16 v18, v40, v4, 0
v_dot2_f32_bf16 v19, v44, v4, 0
v_dot2_f32_bf16 v20, v48, v4, 0
v_dot2_f32_bf16 v21, v52, v4, 0
v_dot2c_f32_bf16 v18, v41, v5
v_dot2c_f32_bf16 v19, v45, v5
v_dot2c_f32_bf16 v20, v49, v5
v_dot2c_f32_bf16 v21, v53, v5
v_dot2c_f32_bf16 v18, v42, v6
v_dot2c_f32_bf16 v19, v46, v6
v_dot2c_f32_bf16 v20, v50, v6
v_dot2c_f32_bf16 v21, v54, v6
v_dot2c_f32_bf16 v18, v43, v7
v_dot2c_f32_bf16 v19, v47, v7
v_dot2c_f32_bf16 v20, v51, v7
v_dot2c_f32_bf16 v21, v55, v7
buffer_load_dwordx4 v[40:43], v1, s[8:11], s57 offen offset:0 nt
buffer_load_dwordx4 v[44:47], v1, s[8:11], s57 offen offset:1024 nt
buffer_load_dwordx4 v[48:51], v1, s[8:11], s57 offen offset:2048 nt
buffer_load_dwordx4 v[52:55], v1, s[8:11], s57 offen offset:3072 nt
v_add_f32_dpp v18, v18, v18 row_ror:8 row_mask:0xf bank_mask:0xf
v_add_f32_dpp v19, v19, v19 row_ror:8 row_mask:0xf bank_mask:0xf
v_add_f32_dpp v20, v20, v20 row_ror:8 row_mask:0xf bank_mask:0xf
v_add_f32_dpp v21, v21, v21 row_ror:8 row_mask:0xf bank_mask:0xf
v_add_f32_dpp v18, v18, v18 row_ror:4 row_mask:0xf bank_mask:0xf
v_add_f32_dpp v19, v19, v19 row_ror:4 row_mask:0xf bank_mask:0xf
v_add_f32_dpp v20, v20, v20 row_ror:4 row_mask:0xf bank_mask:0xf
v_add_f32_dpp v21, v21, v21 row_ror:4 row_mask:0xf bank_mask:0xf
v_add_f32_dpp v18, v18, v18 row_ror:2 row_mask:0xf bank_mask:0xf
v_add_f32_dpp v19, v19, v19 row_ror:2 row_mask:0xf bank_mask:0xf
v_add_f32_dpp v20, v20, v20 row_ror:2 row_mask:0xf bank_mask:0xf
v_add_f32_dpp v21, v21, v21 row_ror:2 row_mask:0xf bank_mask:0xf
v_add_f32_dpp v18, v18, v18 row_ror:1 row_mask:0xf bank_mask:0xf
v_add_f32_dpp v19, v19, v19 row_ror:1 row_mask:0xf bank_mask:0xf
v_add_f32_dpp v20, v20, v20 row_ror:1 row_mask:0xf bank_mask:0xf
v_add_f32_dpp v21, v21, v21 row_ror:1 row_mask:0xf bank_mask:0xf
v_cvt_pk_bf16_f32 v22, v18, v19
v_cvt_pk_bf16_f32 v23, v20, v21
v_lshlrev_b32 v18, 16, v22
v_and_b32 v19, 0xffff0000, v22
v_lshlrev_b32 v20, 16, v23
v_and_b32 v21, 0xffff0000, v23
v_mul_f32 v18, 0x3db504f3, v18
v_mul_f32 v19, 0x3db504f3, v19
v_mul_f32 v20, 0x3db504f3, v20
v_mul_f32 v21, 0x3db504f3, v21
v_cvt_pk_bf16_f32 v22, v18, v19
v_cvt_pk_bf16_f32 v23, v20, v21
v_lshlrev_b32 v18, 16, v22
v_and_b32 v19, 0xffff0000, v22
v_lshlrev_b32 v20, 16, v23
v_and_b32 v21, 0xffff0000, v23
v_max3_f32 v22, v16, v18, v19
v_max3_f32 v22, v22, v20, v21
v_sub_f32 v23, v16, v22
v_mov_b32 v16, v22
v_mul_f32 v23, s24, v23
v_mul_f32 v22, s24, v22
v_exp_f32 v24, v23
v_fma_f32 v18, v18, s24, -v22
v_fma_f32 v19, v19, s24, -v22
v_fma_f32 v20, v20, s24, -v22
v_fma_f32 v21, v21, s24, -v22
v_exp_f32 v18, v18
v_exp_f32 v19, v19
v_exp_f32 v20, v20
v_exp_f32 v21, v21
v_pk_mul_f32 v[8:9], v[8:9], v[24:25] op_sel_hi:[1,0]
v_pk_mul_f32 v[10:11], v[10:11], v[24:25] op_sel_hi:[1,0]
v_pk_mul_f32 v[12:13], v[12:13], v[24:25] op_sel_hi:[1,0]
v_pk_mul_f32 v[14:15], v[14:15], v[24:25] op_sel_hi:[1,0]
v_fma_f32 v17, v17, v24, v18
v_add_f32 v17, v17, v19
v_add_f32 v17, v17, v20
v_add_f32 v17, v17, v21
v_lshlrev_b32 v26, 16, v56
v_and_b32 v27, s25, v56
v_lshlrev_b32 v28, 16, v57
v_and_b32 v29, s25, v57
v_lshlrev_b32 v30, 16, v58
v_and_b32 v31, s25, v58
v_lshlrev_b32 v32, 16, v59
v_and_b32 v33, s25, v59
v_pk_fma_f32 v[8:9], v[26:27], v[18:19], v[8:9] op_sel:[0,0,0] op_sel_hi:[1,0,1]
v_pk_fma_f32 v[10:11], v[28:29], v[18:19], v[10:11] op_sel:[0,0,0] op_sel_hi:[1,0,1]
v_pk_fma_f32 v[12:13], v[30:31], v[18:19], v[12:13] op_sel:[0,0,0] op_sel_hi:[1,0,1]
v_pk_fma_f32 v[14:15], v[32:33], v[18:19], v[14:15] op_sel:[0,0,0] op_sel_hi:[1,0,1]
v_lshlrev_b32 v26, 16, v60
v_and_b32 v27, s25, v60
v_lshlrev_b32 v28, 16, v61
v_and_b32 v29, s25, v61
v_lshlrev_b32 v30, 16, v62
v_and_b32 v31, s25, v62
v_lshlrev_b32 v32, 16, v63
v_and_b32 v33, s25, v63
v_pk_fma_f32 v[8:9], v[26:27], v[18:19], v[8:9] op_sel:[0,1,0] op_sel_hi:[1,1,1]
v_pk_fma_f32 v[10:11], v[28:29], v[18:19], v[10:11] op_sel:[0,1,0] op_sel_hi:[1,1,1]
v_pk_fma_f32 v[12:13], v[30:31], v[18:19], v[12:13] op_sel:[0,1,0] op_sel_hi:[1,1,1]
v_pk_fma_f32 v[14:15], v[32:33], v[18:19], v[14:15] op_sel:[0,1,0] op_sel_hi:[1,1,1]
v_lshlrev_b32 v26, 16, v64
v_and_b32 v27, s25, v64
v_lshlrev_b32 v28, 16, v65
v_and_b32 v29, s25, v65
v_lshlrev_b32 v30, 16, v66
v_and_b32 v31, s25, v66
v_lshlrev_b32 v32, 16, v67
v_and_b32 v33, s25, v67
v_pk_fma_f32 v[8:9], v[26:27], v[20:21], v[8:9] op_sel:[0,0,0] op_sel_hi:[1,0,1]
v_pk_fma_f32 v[10:11], v[28:29], v[20:21], v[10:11] op_sel:[0,0,0] op_sel_hi:[1,0,1]
v_pk_fma_f32 v[12:13], v[30:31], v[20:21], v[12:13] op_sel:[0,0,0] op_sel_hi:[1,0,1]
v_pk_fma_f32 v[14:15], v[32:33], v[20:21], v[14:15] op_sel:[0,0,0] op_sel_hi:[1,0,1]
v_lshlrev_b32 v26, 16, v68
v_and_b32 v27, s25, v68
v_lshlrev_b32 v28, 16, v69
v_and_b32 v29, s25, v69
v_lshlrev_b32 v30, 16, v70
v_and_b32 v31, s25, v70
v_lshlrev_b32 v32, 16, v71
v_and_b32 v33, s25, v71
v_pk_fma_f32 v[8:9], v[26:27], v[20:21], v[8:9] op_sel:[0,1,0] op_sel_hi:[1,1,1]
v_pk_fma_f32 v[10:11], v[28:29], v[20:21], v[10:11] op_sel:[0,1,0] op_sel_hi:[1,1,1]
v_pk_fma_f32 v[12:13], v[30:31], v[20:21], v[12:13] op_sel:[0,1,0] op_sel_hi:[1,1,1]
v_pk_fma_f32 v[14:15], v[32:33], v[20:21], v[14:15] op_sel:[0,1,0] op_sel_hi:[1,1,1]
buffer_load_dwordx4 v[56:59], v1, s[12:15], s57 offen offset:0 nt
buffer_load_dwordx4 v[60:63], v1, s[12:15], s57 offen offset:1024 nt
buffer_load_dwordx4 v[64:67], v1, s[12:15], s57 offen offset:2048 nt
buffer_load_dwordx4 v[68:71], v1, s[12:15], s57 offen offset:3072 nt
s_add_u32 s57, s57, 16384
v_dot2_f32_bf16 v18, v72, v4, 0
v_dot2_f32_bf16 v19, v76, v4, 0
v_dot2_f32_bf16 v20, v80, v4, 0
v_dot2_f32_bf16 v21, v84, v4, 0
v_dot2c_f32_bf16 v18, v73, v5
v_dot2c_f32_bf16 v19, v77, v5
v_dot2c_f32_bf16 v20, v81, v5
v_dot2c_f32_bf16 v21, v85, v5
v_dot2c_f32_bf16 v18, v74, v6
v_dot2c_f32_bf16 v19, v78, v6
v_dot2c_f32_bf16 v20, v82, v6
v_dot2c_f32_bf16 v21, v86, v6
v_dot2c_f32_bf16 v18, v75, v7
v_dot2c_f32_bf16 v19, v79, v7
v_dot2c_f32_bf16 v20, v83, v7
v_dot2c_f32_bf16 v21, v87, v7
s_nop 2
v_add_f32_dpp v18, v18, v18 row_ror:8 row_mask:0xf bank_mask:0xf
v_add_f32_dpp v19, v19, v19 row_ror:8 row_mask:0xf bank_mask:0xf
v_add_f32_dpp v20, v20, v20 row_ror:8 row_mask:0xf bank_mask:0xf
v_add_f32_dpp v21, v21, v21 row_ror:8 row_mask:0xf bank_mask:0xf
v_add_f32_dpp v18, v18, v18 row_ror:4 row_mask:0xf bank_mask:0xf
v_add_f32_dpp v19, v19, v19 row_ror:4 row_mask:0xf bank_mask:0xf
v_add_f32_dpp v20, v20, v20 row_ror:4 row_mask:0xf bank_mask:0xf
v_add_f32_dpp v21, v21, v21 row_ror:4 row_mask:0xf bank_mask:0xf
v_add_f32_dpp v18, v18, v18 row_ror:2 row_mask:0xf bank_mask:0xf
v_add_f32_dpp v19, v19, v19 row_ror:2 row_mask:0xf bank_mask:0xf
v_add_f32_dpp v20, v20, v20 row_ror:2 row_mask:0xf bank_mask:0xf
v_add_f32_dpp v21, v21, v21 row_ror:2 row_mask:0xf bank_mask:0xf
v_add_f32_dpp v18, v18, v18 row_ror:1 row_mask:0xf bank_mask:0xf
v_add_f32_dpp v19, v19, v19 row_ror:1 row_mask:0xf bank_mask:0xf
v_add_f32_dpp v20, v20, v20 row_ror:1 row_mask:0xf bank_mask:0xf
v_add_f32_dpp v21, v21, v21 row_ror:1 row_mask:0xf bank_mask:0xf
v_cvt_pk_bf16_f32 v22, v18, v19
v_cvt_pk_bf16_f32 v23, v20, v21
v_lshlrev_b32 v18, 16, v22
v_and_b32 v19, 0xffff0000, v22
v_lshlrev_b32 v20, 16, v23
v_and_b32 v21, 0xffff0000, v23
v_mul_f32 v18, 0x3db504f3, v18
v_mul_f32 v19, 0x3db504f3, v19
v_mul_f32 v20, 0x3db504f3, v20
v_mul_f32 v21, 0x3db504f3, v21
v_cvt_pk_bf16_f32 v22, v18, v19
v_cvt_pk_bf16_f32 v23, v20, v21
v_lshlrev_b32 v18, 16, v22
v_and_b32 v19, 0xffff0000, v22
v_lshlrev_b32 v20, 16, v23
v_and_b32 v21, 0xffff0000, v23
v_max3_f32 v22, v16, v18, v19
v_max3_f32 v22, v22, v20, v21
v_sub_f32 v23, v16, v22
v_mov_b32 v16, v22
v_mul_f32 v23, s24, v23
v_mul_f32 v22, s24, v22
v_exp_f32 v24, v23
v_fma_f32 v18, v18, s24, -v22
v_fma_f32 v19, v19, s24, -v22
v_fma_f32 v20, v20, s24, -v22
v_fma_f32 v21, v21, s24, -v22
v_exp_f32 v18, v18
v_exp_f32 v19, v19
v_exp_f32 v20, v20
v_exp_f32 v21, v21
v_pk_mul_f32 v[8:9], v[8:9], v[24:25] op_sel_hi:[1,0]
v_pk_mul_f32 v[10:11], v[10:11], v[24:25] op_sel_hi:[1,0]
v_pk_mul_f32 v[12:13], v[12:13], v[24:25] op_sel_hi:[1,0]
v_pk_mul_f32 v[14:15], v[14:15], v[24:25] op_sel_hi:[1,0]
v_fma_f32 v17, v17, v24, v18
v_add_f32 v17, v17, v19
v_add_f32 v17, v17, v20
v_add_f32 v17, v17, v21
v_lshlrev_b32 v26, 16, v88
v_and_b32 v27, s25, v88
v_lshlrev_b32 v28, 16, v89
v_and_b32 v29, s25, v89
v_lshlrev_b32 v30, 16, v90
v_and_b32 v31, s25, v90
v_lshlrev_b32 v32, 16, v91
v_and_b32 v33, s25, v91
v_pk_fma_f32 v[8:9], v[26:27], v[18:19], v[8:9] op_sel:[0,0,0] op_sel_hi:[1,0,1]
v_pk_fma_f32 v[10:11], v[28:29], v[18:19], v[10:11] op_sel:[0,0,0] op_sel_hi:[1,0,1]
v_pk_fma_f32 v[12:13], v[30:31], v[18:19], v[12:13] op_sel:[0,0,0] op_sel_hi:[1,0,1]
v_pk_fma_f32 v[14:15], v[32:33], v[18:19], v[14:15] op_sel:[0,0,0] op_sel_hi:[1,0,1]
v_lshlrev_b32 v26, 16, v92
v_and_b32 v27, s25, v92
v_lshlrev_b32 v28, 16, v93
v_and_b32 v29, s25, v93
v_lshlrev_b32 v30, 16, v94
v_and_b32 v31, s25, v94
v_lshlrev_b32 v32, 16, v95
v_and_b32 v33, s25, v95
v_pk_fma_f32 v[8:9], v[26:27], v[18:19], v[8:9] op_sel:[0,1,0] op_sel_hi:[1,1,1]
v_pk_fma_f32 v[10:11], v[28:29], v[18:19], v[10:11] op_sel:[0,1,0] op_sel_hi:[1,1,1]
v_pk_fma_f32 v[12:13], v[30:31], v[18:19], v[12:13] op_sel:[0,1,0] op_sel_hi:[1,1,1]
v_pk_fma_f32 v[14:15], v[32:33], v[18:19], v[14:15] op_sel:[0,1,0] op_sel_hi:[1,1,1]
v_lshlrev_b32 v26, 16, v96
v_and_b32 v27, s25, v96
v_lshlrev_b32 v28, 16, v97
v_and_b32 v29, s25, v97
v_lshlrev_b32 v30, 16, v98
v_and_b32 v31, s25, v98
v_lshlrev_b32 v32, 16, v99
v_and_b32 v33, s25, v99
v_pk_fma_f32 v[8:9], v[26:27], v[20:21], v[8:9] op_sel:[0,0,0] op_sel_hi:[1,0,1]
v_pk_fma_f32 v[10:11], v[28:29], v[20:21], v[10:11] op_sel:[0,0,0] op_sel_hi:[1,0,1]
v_pk_fma_f32 v[12:13], v[30:31], v[20:21], v[12:13] op_sel:[0,0,0] op_sel_hi:[1,0,1]
v_pk_fma_f32 v[14:15], v[32:33], v[20:21], v[14:15] op_sel:[0,0,0] op_sel_hi:[1,0,1]
v_lshlrev_b32 v26, 16, v100
v_and_b32 v27, s25, v100
v_lshlrev_b32 v28, 16, v101
v_and_b32 v29, s25, v101
v_lshlrev_b32 v30, 16, v102
v_and_b32 v31, s25, v102
v_lshlrev_b32 v32, 16, v103
v_and_b32 v33, s25, v103
v_pk_fma_f32 v[8:9], v[26:27], v[20:21], v[8:9] op_sel:[0,1,0] op_sel_hi:[1,1,1]
v_pk_fma_f32 v[10:11], v[28:29], v[20:21], v[10:11] op_sel:[0,1,0] op_sel_hi:[1,1,1]
v_pk_fma_f32 v[12:13], v[30:31], v[20:21], v[12:13] op_sel:[0,1,0] op_sel_hi:[1,1,1]
v_pk_fma_f32 v[14:15], v[32:33], v[20:21], v[14:15] op_sel:[0,1,0] op_sel_hi:[1,1,1]
s_waitcnt vmcnt(4)
v_dot2_f32_bf16 v18, v40, v4, 0
v_dot2_f32_bf16 v19, v44, v4, 0
v_dot2_f32_bf16 v20, v48, v4, 0
v_dot2_f32_bf16 v21, v52, v4, 0
v_dot2c_f32_bf16 v18, v41, v5
v_dot2c_f32_bf16 v19, v45, v5
v_dot2c_f32_bf16 v20, v49, v5
v_dot2c_f32_bf16 v21, v53, v5
v_dot2c_f32_bf16 v18, v42, v6
v_dot2c_f32_bf16 v19, v46, v6
v_dot2c_f32_bf16 v20, v50, v6
v_dot2c_f32_bf16 v21, v54, v6
v_dot2c_f32_bf16 v18, v43, v7
v_dot2c_f32_bf16 v19, v47, v7
v_dot2c_f32_bf16 v20, v51, v7
v_dot2c_f32_bf16 v21, v55, v7
buffer_load_dwordx4 v[40:43], v1, s[8:11], s57 offen offset:0 nt
buffer_load_dwordx4 v[44:47], v1, s[8:11], s57 offen offset:1024 nt
buffer_load_dwordx4 v[48:51], v1, s[8:11], s57 offen offset:2048 nt
buffer_load_dwordx4 v[52:55], v1, s[8:11], s57 offen offset:3072 nt
v_add_f32_dpp v18, v18, v18 row_ror:8 row_mask:0xf bank_mask:0xf
v_add_f32_dpp v19, v19, v19 row_ror:8 row_mask:0xf bank_mask:0xf
v_add_f32_dpp v20, v20, v20 row_ror:8 row_mask:0xf bank_mask:0xf
v_add_f32_dpp v21, v21, v21 row_ror:8 row_mask:0xf bank_mask:0xf
v_add_f32_dpp v18, v18, v18 row_ror:4 row_mask:0xf bank_mask:0xf
v_add_f32_dpp v19, v19, v19 row_ror:4 row_mask:0xf bank_mask:0xf
v_add_f32_dpp v20, v20, v20 row_ror:4 row_mask:0xf bank_mask:0xf
v_add_f32_dpp v21, v21, v21 row_ror:4 row_mask:0xf bank_mask:0xf
v_add_f32_dpp v18, v18, v18 row_ror:2 row_mask:0xf bank_mask:0xf
v_add_f32_dpp v19, v19, v19 row_ror:2 row_mask:0xf bank_mask:0xf
v_add_f32_dpp v20, v20, v20 row_ror:2 row_mask:0xf bank_mask:0xf
v_add_f32_dpp v21, v21, v21 row_ror:2 row_mask:0xf bank_mask:0xf
v_add_f32_dpp v18, v18, v18 row_ror:1 row_mask:0xf bank_mask:0xf
v_add_f32_dpp v19, v19, v19 row_ror:1 row_mask:0xf bank_mask:0xf
v_add_f32_dpp v20, v20, v20 row_ror:1 row_mask:0xf bank_mask:0xf
v_add_f32_dpp v21, v21, v21 row_ror:1 row_mask:0xf bank_mask:0xf
v_cvt_pk_bf16_f32 v22, v18, v19
v_cvt_pk_bf16_f32 v23, v20, v21
v_lshlrev_b32 v18, 16, v22
v_and_b32 v19, 0xffff0000, v22
v_lshlrev_b32 v20, 16, v23
v_and_b32 v21, 0xffff0000, v23
v_mul_f32 v18, 0x3db504f3, v18
v_mul_f32 v19, 0x3db504f3, v19
v_mul_f32 v20, 0x3db504f3, v20
v_mul_f32 v21, 0x3db504f3, v21
v_cvt_pk_bf16_f32 v22, v18, v19
v_cvt_pk_bf16_f32 v23, v20, v21
v_lshlrev_b32 v18, 16, v22
v_and_b32 v19, 0xffff0000, v22
v_lshlrev_b32 v20, 16, v23
v_and_b32 v21, 0xffff0000, v23
v_max3_f32 v22, v16, v18, v19
v_max3_f32 v22, v22, v20, v21
v_sub_f32 v23, v16, v22
v_mov_b32 v16, v22
v_mul_f32 v23, s24, v23
v_mul_f32 v22, s24, v22
v_exp_f32 v24, v23
v_fma_f32 v18, v18, s24, -v22
v_fma_f32 v19, v19, s24, -v22
v_fma_f32 v20, v20, s24, -v22
v_fma_f32 v21, v21, s24, -v22
v_exp_f32 v18, v18
v_exp_f32 v19, v19
v_exp_f32 v20, v20
v_exp_f32 v21, v21
v_pk_mul_f32 v[8:9], v[8:9], v[24:25] op_sel_hi:[1,0]
v_pk_mul_f32 v[10:11], v[10:11], v[24:25] op_sel_hi:[1,0]
v_pk_mul_f32 v[12:13], v[12:13], v[24:25] op_sel_hi:[1,0]
v_pk_mul_f32 v[14:15], v[14:15], v[24:25] op_sel_hi:[1,0]
v_fma_f32 v17, v17, v24, v18
v_add_f32 v17, v17, v19
v_add_f32 v17, v17, v20
v_add_f32 v17, v17, v21
s_waitcnt vmcnt(4)
v_lshlrev_b32 v26, 16, v56
v_and_b32 v27, s25, v56
v_lshlrev_b32 v28, 16, v57
v_and_b32 v29, s25, v57
v_lshlrev_b32 v30, 16, v58
v_and_b32 v31, s25, v58
v_lshlrev_b32 v32, 16, v59
v_and_b32 v33, s25, v59
v_pk_fma_f32 v[8:9], v[26:27], v[18:19], v[8:9] op_sel:[0,0,0] op_sel_hi:[1,0,1]
v_pk_fma_f32 v[10:11], v[28:29], v[18:19], v[10:11] op_sel:[0,0,0] op_sel_hi:[1,0,1]
v_pk_fma_f32 v[12:13], v[30:31], v[18:19], v[12:13] op_sel:[0,0,0] op_sel_hi:[1,0,1]
v_pk_fma_f32 v[14:15], v[32:33], v[18:19], v[14:15] op_sel:[0,0,0] op_sel_hi:[1,0,1]
v_lshlrev_b32 v26, 16, v60
v_and_b32 v27, s25, v60
v_lshlrev_b32 v28, 16, v61
v_and_b32 v29, s25, v61
v_lshlrev_b32 v30, 16, v62
v_and_b32 v31, s25, v62
v_lshlrev_b32 v32, 16, v63
v_and_b32 v33, s25, v63
v_pk_fma_f32 v[8:9], v[26:27], v[18:19], v[8:9] op_sel:[0,1,0] op_sel_hi:[1,1,1]
v_pk_fma_f32 v[10:11], v[28:29], v[18:19], v[10:11] op_sel:[0,1,0] op_sel_hi:[1,1,1]
v_pk_fma_f32 v[12:13], v[30:31], v[18:19], v[12:13] op_sel:[0,1,0] op_sel_hi:[1,1,1]
v_pk_fma_f32 v[14:15], v[32:33], v[18:19], v[14:15] op_sel:[0,1,0] op_sel_hi:[1,1,1]
v_lshlrev_b32 v26, 16, v64
v_and_b32 v27, s25, v64
v_lshlrev_b32 v28, 16, v65
v_and_b32 v29, s25, v65
v_lshlrev_b32 v30, 16, v66
v_and_b32 v31, s25, v66
v_lshlrev_b32 v32, 16, v67
v_and_b32 v33, s25, v67
v_pk_fma_f32 v[8:9], v[26:27], v[20:21], v[8:9] op_sel:[0,0,0] op_sel_hi:[1,0,1]
v_pk_fma_f32 v[10:11], v[28:29], v[20:21], v[10:11] op_sel:[0,0,0] op_sel_hi:[1,0,1]
v_pk_fma_f32 v[12:13], v[30:31], v[20:21], v[12:13] op_sel:[0,0,0] op_sel_hi:[1,0,1]
v_pk_fma_f32 v[14:15], v[32:33], v[20:21], v[14:15] op_sel:[0,0,0] op_sel_hi:[1,0,1]
v_lshlrev_b32 v26, 16, v68
v_and_b32 v27, s25, v68
v_lshlrev_b32 v28, 16, v69
v_and_b32 v29, s25, v69
v_lshlrev_b32 v30, 16, v70
v_and_b32 v31, s25, v70
v_lshlrev_b32 v32, 16, v71
v_and_b32 v33, s25, v71
v_pk_fma_f32 v[8:9], v[26:27], v[20:21], v[8:9] op_sel:[0,1,0] op_sel_hi:[1,1,1]
v_pk_fma_f32 v[10:11], v[28:29], v[20:21], v[10:11] op_sel:[0,1,0] op_sel_hi:[1,1,1]
v_pk_fma_f32 v[12:13], v[30:31], v[20:21], v[12:13] op_sel:[0,1,0] op_sel_hi:[1,1,1]
v_pk_fma_f32 v[14:15], v[32:33], v[20:21], v[14:15] op_sel:[0,1,0] op_sel_hi:[1,1,1]
buffer_load_dwordx4 v[56:59], v1, s[12:15], s57 offen offset:0 nt
buffer_load_dwordx4 v[60:63], v1, s[12:15], s57 offen offset:1024 nt
buffer_load_dwordx4 v[64:67], v1, s[12:15], s57 offen offset:2048 nt
buffer_load_dwordx4 v[68:71], v1, s[12:15], s57 offen offset:3072 nt
s_add_u32 s57, s57, 16384
v_dot2_f32_bf16 v18, v104, v4, 0
v_dot2_f32_bf16 v19, v108, v4, 0
v_dot2_f32_bf16 v20, v112, v4, 0
v_dot2_f32_bf16 v21, v116, v4, 0
v_dot2c_f32_bf16 v18, v105, v5
v_dot2c_f32_bf16 v19, v109, v5
v_dot2c_f32_bf16 v20, v113, v5
v_dot2c_f32_bf16 v21, v117, v5
v_dot2c_f32_bf16 v18, v106, v6
v_dot2c_f32_bf16 v19, v110, v6
v_dot2c_f32_bf16 v20, v114, v6
v_dot2c_f32_bf16 v21, v118, v6
v_dot2c_f32_bf16 v18, v107, v7
v_dot2c_f32_bf16 v19, v111, v7
v_dot2c_f32_bf16 v20, v115, v7
v_dot2c_f32_bf16 v21, v119, v7
s_nop 2
v_add_f32_dpp v18, v18, v18 row_ror:8 row_mask:0xf bank_mask:0xf
v_add_f32_dpp v19, v19, v19 row_ror:8 row_mask:0xf bank_mask:0xf
v_add_f32_dpp v20, v20, v20 row_ror:8 row_mask:0xf bank_mask:0xf
v_add_f32_dpp v21, v21, v21 row_ror:8 row_mask:0xf bank_mask:0xf
v_add_f32_dpp v18, v18, v18 row_ror:4 row_mask:0xf bank_mask:0xf
v_add_f32_dpp v19, v19, v19 row_ror:4 row_mask:0xf bank_mask:0xf
v_add_f32_dpp v20, v20, v20 row_ror:4 row_mask:0xf bank_mask:0xf
v_add_f32_dpp v21, v21, v21 row_ror:4 row_mask:0xf bank_mask:0xf
v_add_f32_dpp v18, v18, v18 row_ror:2 row_mask:0xf bank_mask:0xf
v_add_f32_dpp v19, v19, v19 row_ror:2 row_mask:0xf bank_mask:0xf
v_add_f32_dpp v20, v20, v20 row_ror:2 row_mask:0xf bank_mask:0xf
v_add_f32_dpp v21, v21, v21 row_ror:2 row_mask:0xf bank_mask:0xf
v_add_f32_dpp v18, v18, v18 row_ror:1 row_mask:0xf bank_mask:0xf
v_add_f32_dpp v19, v19, v19 row_ror:1 row_mask:0xf bank_mask:0xf
v_add_f32_dpp v20, v20, v20 row_ror:1 row_mask:0xf bank_mask:0xf
v_add_f32_dpp v21, v21, v21 row_ror:1 row_mask:0xf bank_mask:0xf
v_cvt_pk_bf16_f32 v22, v18, v19
v_cvt_pk_bf16_f32 v23, v20, v21
v_lshlrev_b32 v18, 16, v22
v_and_b32 v19, 0xffff0000, v22
v_lshlrev_b32 v20, 16, v23
v_and_b32 v21, 0xffff0000, v23
v_mul_f32 v18, 0x3db504f3, v18
v_mul_f32 v19, 0x3db504f3, v19
v_mul_f32 v20, 0x3db504f3, v20
v_mul_f32 v21, 0x3db504f3, v21
v_cvt_pk_bf16_f32 v22, v18, v19
v_cvt_pk_bf16_f32 v23, v20, v21
v_lshlrev_b32 v18, 16, v22
v_and_b32 v19, 0xffff0000, v22
v_lshlrev_b32 v20, 16, v23
v_and_b32 v21, 0xffff0000, v23
v_max3_f32 v22, v16, v18, v19
v_max3_f32 v22, v22, v20, v21
v_sub_f32 v23, v16, v22
v_mov_b32 v16, v22
v_mul_f32 v23, s24, v23
v_mul_f32 v22, s24, v22
v_exp_f32 v24, v23
v_fma_f32 v18, v18, s24, -v22
v_fma_f32 v19, v19, s24, -v22
v_fma_f32 v20, v20, s24, -v22
v_fma_f32 v21, v21, s24, -v22
v_exp_f32 v18, v18
v_exp_f32 v19, v19
v_exp_f32 v20, v20
v_exp_f32 v21, v21
v_pk_mul_f32 v[8:9], v[8:9], v[24:25] op_sel_hi:[1,0]
v_pk_mul_f32 v[10:11], v[10:11], v[24:25] op_sel_hi:[1,0]
v_pk_mul_f32 v[12:13], v[12:13], v[24:25] op_sel_hi:[1,0]
v_pk_mul_f32 v[14:15], v[14:15], v[24:25] op_sel_hi:[1,0]
v_fma_f32 v17, v17, v24, v18
v_add_f32 v17, v17, v19
v_add_f32 v17, v17, v20
v_add_f32 v17, v17, v21
v_lshlrev_b32 v26, 16, v120
v_and_b32 v27, s25, v120
v_lshlrev_b32 v28, 16, v121
v_and_b32 v29, s25, v121
v_lshlrev_b32 v30, 16, v122
v_and_b32 v31, s25, v122
v_lshlrev_b32 v32, 16, v123
v_and_b32 v33, s25, v123
v_pk_fma_f32 v[8:9], v[26:27], v[18:19], v[8:9] op_sel:[0,0,0] op_sel_hi:[1,0,1]
v_pk_fma_f32 v[10:11], v[28:29], v[18:19], v[10:11] op_sel:[0,0,0] op_sel_hi:[1,0,1]
v_pk_fma_f32 v[12:13], v[30:31], v[18:19], v[12:13] op_sel:[0,0,0] op_sel_hi:[1,0,1]
v_pk_fma_f32 v[14:15], v[32:33], v[18:19], v[14:15] op_sel:[0,0,0] op_sel_hi:[1,0,1]
v_lshlrev_b32 v26, 16, v124
v_and_b32 v27, s25, v124
v_lshlrev_b32 v28, 16, v125
v_and_b32 v29, s25, v125
v_lshlrev_b32 v30, 16, v126
v_and_b32 v31, s25, v126
v_lshlrev_b32 v32, 16, v127
v_and_b32 v33, s25, v127
v_pk_fma_f32 v[8:9], v[26:27], v[18:19], v[8:9] op_sel:[0,1,0] op_sel_hi:[1,1,1]
v_pk_fma_f32 v[10:11], v[28:29], v[18:19], v[10:11] op_sel:[0,1,0] op_sel_hi:[1,1,1]
v_pk_fma_f32 v[12:13], v[30:31], v[18:19], v[12:13] op_sel:[0,1,0] op_sel_hi:[1,1,1]
v_pk_fma_f32 v[14:15], v[32:33], v[18:19], v[14:15] op_sel:[0,1,0] op_sel_hi:[1,1,1]
v_lshlrev_b32 v26, 16, v128
v_and_b32 v27, s25, v128
v_lshlrev_b32 v28, 16, v129
v_and_b32 v29, s25, v129
v_lshlrev_b32 v30, 16, v130
v_and_b32 v31, s25, v130
v_lshlrev_b32 v32, 16, v131
v_and_b32 v33, s25, v131
v_pk_fma_f32 v[8:9], v[26:27], v[20:21], v[8:9] op_sel:[0,0,0] op_sel_hi:[1,0,1]
v_pk_fma_f32 v[10:11], v[28:29], v[20:21], v[10:11] op_sel:[0,0,0] op_sel_hi:[1,0,1]
v_pk_fma_f32 v[12:13], v[30:31], v[20:21], v[12:13] op_sel:[0,0,0] op_sel_hi:[1,0,1]
v_pk_fma_f32 v[14:15], v[32:33], v[20:21], v[14:15] op_sel:[0,0,0] op_sel_hi:[1,0,1]
v_lshlrev_b32 v26, 16, v132
v_and_b32 v27, s25, v132
v_lshlrev_b32 v28, 16, v133
v_and_b32 v29, s25, v133
v_lshlrev_b32 v30, 16, v134
v_and_b32 v31, s25, v134
v_lshlrev_b32 v32, 16, v135
v_and_b32 v33, s25, v135
v_pk_fma_f32 v[8:9], v[26:27], v[20:21], v[8:9] op_sel:[0,1,0] op_sel_hi:[1,1,1]
v_pk_fma_f32 v[10:11], v[28:29], v[20:21], v[10:11] op_sel:[0,1,0] op_sel_hi:[1,1,1]
v_pk_fma_f32 v[12:13], v[30:31], v[20:21], v[12:13] op_sel:[0,1,0] op_sel_hi:[1,1,1]
v_pk_fma_f32 v[14:15], v[32:33], v[20:21], v[14:15] op_sel:[0,1,0] op_sel_hi:[1,1,1]
s_waitcnt vmcnt(4)
v_dot2_f32_bf16 v18, v40, v4, 0
v_dot2_f32_bf16 v19, v44, v4, 0
v_dot2_f32_bf16 v20, v48, v4, 0
v_dot2_f32_bf16 v21, v52, v4, 0
v_dot2c_f32_bf16 v18, v41, v5
v_dot2c_f32_bf16 v19, v45, v5
v_dot2c_f32_bf16 v20, v49, v5
v_dot2c_f32_bf16 v21, v53, v5
v_dot2c_f32_bf16 v18, v42, v6
v_dot2c_f32_bf16 v19, v46, v6
v_dot2c_f32_bf16 v20, v50, v6
v_dot2c_f32_bf16 v21, v54, v6
v_dot2c_f32_bf16 v18, v43, v7
v_dot2c_f32_bf16 v19, v47, v7
v_dot2c_f32_bf16 v20, v51, v7
v_dot2c_f32_bf16 v21, v55, v7
buffer_load_dwordx4 v[40:43], v1, s[8:11], s57 offen offset:0 nt
buffer_load_dwordx4 v[44:47], v1, s[8:11], s57 offen offset:1024 nt
buffer_load_dwordx4 v[48:51], v1, s[8:11], s57 offen offset:2048 nt
buffer_load_dwordx4 v[52:55], v1, s[8:11], s57 offen offset:3072 nt
v_add_f32_dpp v18, v18, v18 row_ror:8 row_mask:0xf bank_mask:0xf
v_add_f32_dpp v19, v19, v19 row_ror:8 row_mask:0xf bank_mask:0xf
v_add_f32_dpp v20, v20, v20 row_ror:8 row_mask:0xf bank_mask:0xf
v_add_f32_dpp v21, v21, v21 row_ror:8 row_mask:0xf bank_mask:0xf
v_add_f32_dpp v18, v18, v18 row_ror:4 row_mask:0xf bank_mask:0xf
v_add_f32_dpp v19, v19, v19 row_ror:4 row_mask:0xf bank_mask:0xf
v_add_f32_dpp v20, v20, v20 row_ror:4 row_mask:0xf bank_mask:0xf
v_add_f32_dpp v21, v21, v21 row_ror:4 row_mask:0xf bank_mask:0xf
v_add_f32_dpp v18, v18, v18 row_ror:2 row_mask:0xf bank_mask:0xf
v_add_f32_dpp v19, v19, v19 row_ror:2 row_mask:0xf bank_mask:0xf
v_add_f32_dpp v20, v20, v20 row_ror:2 row_mask:0xf bank_mask:0xf
v_add_f32_dpp v21, v21, v21 row_ror:2 row_mask:0xf bank_mask:0xf
v_add_f32_dpp v18, v18, v18 row_ror:1 row_mask:0xf bank_mask:0xf
v_add_f32_dpp v19, v19, v19 row_ror:1 row_mask:0xf bank_mask:0xf
v_add_f32_dpp v20, v20, v20 row_ror:1 row_mask:0xf bank_mask:0xf
v_add_f32_dpp v21, v21, v21 row_ror:1 row_mask:0xf bank_mask:0xf
v_cvt_pk_bf16_f32 v22, v18, v19
v_cvt_pk_bf16_f32 v23, v20, v21
v_lshlrev_b32 v18, 16, v22
v_and_b32 v19, 0xffff0000, v22
v_lshlrev_b32 v20, 16, v23
v_and_b32 v21, 0xffff0000, v23
v_mul_f32 v18, 0x3db504f3, v18
v_mul_f32 v19, 0x3db504f3, v19
v_mul_f32 v20, 0x3db504f3, v20
v_mul_f32 v21, 0x3db504f3, v21
v_cvt_pk_bf16_f32 v22, v18, v19
v_cvt_pk_bf16_f32 v23, v20, v21
v_lshlrev_b32 v18, 16, v22
v_and_b32 v19, 0xffff0000, v22
v_lshlrev_b32 v20, 16, v23
v_and_b32 v21, 0xffff0000, v23
v_max3_f32 v22, v16, v18, v19
v_max3_f32 v22, v22, v20, v21
v_sub_f32 v23, v16, v22
v_mov_b32 v16, v22
v_mul_f32 v23, s24, v23
v_mul_f32 v22, s24, v22
v_exp_f32 v24, v23
v_fma_f32 v18, v18, s24, -v22
v_fma_f32 v19, v19, s24, -v22
v_fma_f32 v20, v20, s24, -v22
v_fma_f32 v21, v21, s24, -v22
v_exp_f32 v18, v18
v_exp_f32 v19, v19
v_exp_f32 v20, v20
v_exp_f32 v21, v21
v_pk_mul_f32 v[8:9], v[8:9], v[24:25] op_sel_hi:[1,0]
v_pk_mul_f32 v[10:11], v[10:11], v[24:25] op_sel_hi:[1,0]
v_pk_mul_f32 v[12:13], v[12:13], v[24:25] op_sel_hi:[1,0]
v_pk_mul_f32 v[14:15], v[14:15], v[24:25] op_sel_hi:[1,0]
v_fma_f32 v17, v17, v24, v18
v_add_f32 v17, v17, v19
v_add_f32 v17, v17, v20
v_add_f32 v17, v17, v21
s_waitcnt vmcnt(4)
v_lshlrev_b32 v26, 16, v56
v_and_b32 v27, s25, v56
v_lshlrev_b32 v28, 16, v57
v_and_b32 v29, s25, v57
v_lshlrev_b32 v30, 16, v58
v_and_b32 v31, s25, v58
v_lshlrev_b32 v32, 16, v59
v_and_b32 v33, s25, v59
v_pk_fma_f32 v[8:9], v[26:27], v[18:19], v[8:9] op_sel:[0,0,0] op_sel_hi:[1,0,1]
v_pk_fma_f32 v[10:11], v[28:29], v[18:19], v[10:11] op_sel:[0,0,0] op_sel_hi:[1,0,1]
v_pk_fma_f32 v[12:13], v[30:31], v[18:19], v[12:13] op_sel:[0,0,0] op_sel_hi:[1,0,1]
v_pk_fma_f32 v[14:15], v[32:33], v[18:19], v[14:15] op_sel:[0,0,0] op_sel_hi:[1,0,1]
v_lshlrev_b32 v26, 16, v60
v_and_b32 v27, s25, v60
v_lshlrev_b32 v28, 16, v61
v_and_b32 v29, s25, v61
v_lshlrev_b32 v30, 16, v62
v_and_b32 v31, s25, v62
v_lshlrev_b32 v32, 16, v63
v_and_b32 v33, s25, v63
v_pk_fma_f32 v[8:9], v[26:27], v[18:19], v[8:9] op_sel:[0,1,0] op_sel_hi:[1,1,1]
v_pk_fma_f32 v[10:11], v[28:29], v[18:19], v[10:11] op_sel:[0,1,0] op_sel_hi:[1,1,1]
v_pk_fma_f32 v[12:13], v[30:31], v[18:19], v[12:13] op_sel:[0,1,0] op_sel_hi:[1,1,1]
v_pk_fma_f32 v[14:15], v[32:33], v[18:19], v[14:15] op_sel:[0,1,0] op_sel_hi:[1,1,1]
v_lshlrev_b32 v26, 16, v64
v_and_b32 v27, s25, v64
v_lshlrev_b32 v28, 16, v65
v_and_b32 v29, s25, v65
v_lshlrev_b32 v30, 16, v66
v_and_b32 v31, s25, v66
v_lshlrev_b32 v32, 16, v67
v_and_b32 v33, s25, v67
v_pk_fma_f32 v[8:9], v[26:27], v[20:21], v[8:9] op_sel:[0,0,0] op_sel_hi:[1,0,1]
v_pk_fma_f32 v[10:11], v[28:29], v[20:21], v[10:11] op_sel:[0,0,0] op_sel_hi:[1,0,1]
v_pk_fma_f32 v[12:13], v[30:31], v[20:21], v[12:13] op_sel:[0,0,0] op_sel_hi:[1,0,1]
v_pk_fma_f32 v[14:15], v[32:33], v[20:21], v[14:15] op_sel:[0,0,0] op_sel_hi:[1,0,1]
v_lshlrev_b32 v26, 16, v68
v_and_b32 v27, s25, v68
v_lshlrev_b32 v28, 16, v69
v_and_b32 v29, s25, v69
v_lshlrev_b32 v30, 16, v70
v_and_b32 v31, s25, v70
v_lshlrev_b32 v32, 16, v71
v_and_b32 v33, s25, v71
v_pk_fma_f32 v[8:9], v[26:27], v[20:21], v[8:9] op_sel:[0,1,0] op_sel_hi:[1,1,1]
v_pk_fma_f32 v[10:11], v[28:29], v[20:21], v[10:11] op_sel:[0,1,0] op_sel_hi:[1,1,1]
v_pk_fma_f32 v[12:13], v[30:31], v[20:21], v[12:13] op_sel:[0,1,0] op_sel_hi:[1,1,1]
v_pk_fma_f32 v[14:15], v[32:33], v[20:21], v[14:15] op_sel:[0,1,0] op_sel_hi:[1,1,1]
buffer_load_dwordx4 v[56:59], v1, s[12:15], s57 offen offset:0 nt
buffer_load_dwordx4 v[60:63], v1, s[12:15], s57 offen offset:1024 nt
buffer_load_dwordx4 v[64:67], v1, s[12:15], s57 offen offset:2048 nt
buffer_load_dwordx4 v[68:71], v1, s[12:15], s57 offen offset:3072 nt
s_add_u32 s57, s57, 16384
v_dot2_f32_bf16 v18, v136, v4, 0
v_dot2_f32_bf16 v19, v140, v4, 0
v_dot2_f32_bf16 v20, v144, v4, 0
v_dot2_f32_bf16 v21, v148, v4, 0
v_dot2c_f32_bf16 v18, v137, v5
v_dot2c_f32_bf16 v19, v141, v5
v_dot2c_f32_bf16 v20, v145, v5
v_dot2c_f32_bf16 v21, v149, v5
v_dot2c_f32_bf16 v18, v138, v6
v_dot2c_f32_bf16 v19, v142, v6
v_dot2c_f32_bf16 v20, v146, v6
v_dot2c_f32_bf16 v21, v150, v6
v_dot2c_f32_bf16 v18, v139, v7
v_dot2c_f32_bf16 v19, v143, v7
v_dot2c_f32_bf16 v20, v147, v7
v_dot2c_f32_bf16 v21, v151, v7
s_nop 2
v_add_f32_dpp v18, v18, v18 row_ror:8 row_mask:0xf bank_mask:0xf
v_add_f32_dpp v19, v19, v19 row_ror:8 row_mask:0xf bank_mask:0xf
v_add_f32_dpp v20, v20, v20 row_ror:8 row_mask:0xf bank_mask:0xf
v_add_f32_dpp v21, v21, v21 row_ror:8 row_mask:0xf bank_mask:0xf
v_add_f32_dpp v18, v18, v18 row_ror:4 row_mask:0xf bank_mask:0xf
v_add_f32_dpp v19, v19, v19 row_ror:4 row_mask:0xf bank_mask:0xf
v_add_f32_dpp v20, v20, v20 row_ror:4 row_mask:0xf bank_mask:0xf
v_add_f32_dpp v21, v21, v21 row_ror:4 row_mask:0xf bank_mask:0xf
v_add_f32_dpp v18, v18, v18 row_ror:2 row_mask:0xf bank_mask:0xf
v_add_f32_dpp v19, v19, v19 row_ror:2 row_mask:0xf bank_mask:0xf
v_add_f32_dpp v20, v20, v20 row_ror:2 row_mask:0xf bank_mask:0xf
v_add_f32_dpp v21, v21, v21 row_ror:2 row_mask:0xf bank_mask:0xf
v_add_f32_dpp v18, v18, v18 row_ror:1 row_mask:0xf bank_mask:0xf
v_add_f32_dpp v19, v19, v19 row_ror:1 row_mask:0xf bank_mask:0xf
v_add_f32_dpp v20, v20, v20 row_ror:1 row_mask:0xf bank_mask:0xf
v_add_f32_dpp v21, v21, v21 row_ror:1 row_mask:0xf bank_mask:0xf
v_cvt_pk_bf16_f32 v22, v18, v19
v_cvt_pk_bf16_f32 v23, v20, v21
v_lshlrev_b32 v18, 16, v22
v_and_b32 v19, 0xffff0000, v22
v_lshlrev_b32 v20, 16, v23
v_and_b32 v21, 0xffff0000, v23
v_mul_f32 v18, 0x3db504f3, v18
v_mul_f32 v19, 0x3db504f3, v19
v_mul_f32 v20, 0x3db504f3, v20
v_mul_f32 v21, 0x3db504f3, v21
v_cvt_pk_bf16_f32 v22, v18, v19
v_cvt_pk_bf16_f32 v23, v20, v21
v_lshlrev_b32 v18, 16, v22
v_and_b32 v19, 0xffff0000, v22
v_lshlrev_b32 v20, 16, v23
v_and_b32 v21, 0xffff0000, v23
v_max3_f32 v22, v16, v18, v19
v_max3_f32 v22, v22, v20, v21
v_sub_f32 v23, v16, v22
v_mov_b32 v16, v22
v_mul_f32 v23, s24, v23
v_mul_f32 v22, s24, v22
v_exp_f32 v24, v23
v_fma_f32 v18, v18, s24, -v22
v_fma_f32 v19, v19, s24, -v22
v_fma_f32 v20, v20, s24, -v22
v_fma_f32 v21, v21, s24, -v22
v_exp_f32 v18, v18
v_exp_f32 v19, v19
v_exp_f32 v20, v20
v_exp_f32 v21, v21
v_pk_mul_f32 v[8:9], v[8:9], v[24:25] op_sel_hi:[1,0]
v_pk_mul_f32 v[10:11], v[10:11], v[24:25] op_sel_hi:[1,0]
v_pk_mul_f32 v[12:13], v[12:13], v[24:25] op_sel_hi:[1,0]
v_pk_mul_f32 v[14:15], v[14:15], v[24:25] op_sel_hi:[1,0]
v_fma_f32 v17, v17, v24, v18
v_add_f32 v17, v17, v19
v_add_f32 v17, v17, v20
v_add_f32 v17, v17, v21
v_lshlrev_b32 v26, 16, v152
v_and_b32 v27, s25, v152
v_lshlrev_b32 v28, 16, v153
v_and_b32 v29, s25, v153
v_lshlrev_b32 v30, 16, v154
v_and_b32 v31, s25, v154
v_lshlrev_b32 v32, 16, v155
v_and_b32 v33, s25, v155
v_pk_fma_f32 v[8:9], v[26:27], v[18:19], v[8:9] op_sel:[0,0,0] op_sel_hi:[1,0,1]
v_pk_fma_f32 v[10:11], v[28:29], v[18:19], v[10:11] op_sel:[0,0,0] op_sel_hi:[1,0,1]
v_pk_fma_f32 v[12:13], v[30:31], v[18:19], v[12:13] op_sel:[0,0,0] op_sel_hi:[1,0,1]
v_pk_fma_f32 v[14:15], v[32:33], v[18:19], v[14:15] op_sel:[0,0,0] op_sel_hi:[1,0,1]
v_lshlrev_b32 v26, 16, v156
v_and_b32 v27, s25, v156
v_lshlrev_b32 v28, 16, v157
v_and_b32 v29, s25, v157
v_lshlrev_b32 v30, 16, v158
v_and_b32 v31, s25, v158
v_lshlrev_b32 v32, 16, v159
v_and_b32 v33, s25, v159
v_pk_fma_f32 v[8:9], v[26:27], v[18:19], v[8:9] op_sel:[0,1,0] op_sel_hi:[1,1,1]
v_pk_fma_f32 v[10:11], v[28:29], v[18:19], v[10:11] op_sel:[0,1,0] op_sel_hi:[1,1,1]
v_pk_fma_f32 v[12:13], v[30:31], v[18:19], v[12:13] op_sel:[0,1,0] op_sel_hi:[1,1,1]
v_pk_fma_f32 v[14:15], v[32:33], v[18:19], v[14:15] op_sel:[0,1,0] op_sel_hi:[1,1,1]
v_lshlrev_b32 v26, 16, v160
v_and_b32 v27, s25, v160
v_lshlrev_b32 v28, 16, v161
v_and_b32 v29, s25, v161
v_lshlrev_b32 v30, 16, v162
v_and_b32 v31, s25, v162
v_lshlrev_b32 v32, 16, v163
v_and_b32 v33, s25, v163
v_pk_fma_f32 v[8:9], v[26:27], v[20:21], v[8:9] op_sel:[0,0,0] op_sel_hi:[1,0,1]
v_pk_fma_f32 v[10:11], v[28:29], v[20:21], v[10:11] op_sel:[0,0,0] op_sel_hi:[1,0,1]
v_pk_fma_f32 v[12:13], v[30:31], v[20:21], v[12:13] op_sel:[0,0,0] op_sel_hi:[1,0,1]
v_pk_fma_f32 v[14:15], v[32:33], v[20:21], v[14:15] op_sel:[0,0,0] op_sel_hi:[1,0,1]
v_lshlrev_b32 v26, 16, v164
v_and_b32 v27, s25, v164
v_lshlrev_b32 v28, 16, v165
v_and_b32 v29, s25, v165
v_lshlrev_b32 v30, 16, v166
v_and_b32 v31, s25, v166
v_lshlrev_b32 v32, 16, v167
v_and_b32 v33, s25, v167
v_pk_fma_f32 v[8:9], v[26:27], v[20:21], v[8:9] op_sel:[0,1,0] op_sel_hi:[1,1,1]
v_pk_fma_f32 v[10:11], v[28:29], v[20:21], v[10:11] op_sel:[0,1,0] op_sel_hi:[1,1,1]
v_pk_fma_f32 v[12:13], v[30:31], v[20:21], v[12:13] op_sel:[0,1,0] op_sel_hi:[1,1,1]
v_pk_fma_f32 v[14:15], v[32:33], v[20:21], v[14:15] op_sel:[0,1,0] op_sel_hi:[1,1,1]
s_waitcnt vmcnt(4)
ds_read_b128 v[72:75], v39 offset:0
ds_read_b128 v[76:79], v39 offset:1024
ds_read_b128 v[80:83], v39 offset:2048
ds_read_b128 v[84:87], v39 offset:3072
ds_read_b128 v[88:91], v39 offset:4096
ds_read_b128 v[92:95], v39 offset:5120
ds_read_b128 v[96:99], v39 offset:6144
ds_read_b128 v[100:103], v39 offset:7168
v_dot2_f32_bf16 v18, v40, v4, 0
v_dot2_f32_bf16 v19, v44, v4, 0
v_dot2_f32_bf16 v20, v48, v4, 0
v_dot2_f32_bf16 v21, v52, v4, 0
v_dot2c_f32_bf16 v18, v41, v5
v_dot2c_f32_bf16 v19, v45, v5
v_dot2c_f32_bf16 v20, v49, v5
v_dot2c_f32_bf16 v21, v53, v5
v_dot2c_f32_bf16 v18, v42, v6
v_dot2c_f32_bf16 v19, v46, v6
v_dot2c_f32_bf16 v20, v50, v6
v_dot2c_f32_bf16 v21, v54, v6
v_dot2c_f32_bf16 v18, v43, v7
v_dot2c_f32_bf16 v19, v47, v7
v_dot2c_f32_bf16 v20, v51, v7
v_dot2c_f32_bf16 v21, v55, v7
buffer_load_dwordx4 v[40:43], v1, s[8:11], s57 offen offset:0 nt
buffer_load_dwordx4 v[44:47], v1, s[8:11], s57 offen offset:1024 nt
buffer_load_dwordx4 v[48:51], v1, s[8:11], s57 offen offset:2048 nt
buffer_load_dwordx4 v[52:55], v1, s[8:11], s57 offen offset:3072 nt
v_add_f32_dpp v18, v18, v18 row_ror:8 row_mask:0xf bank_mask:0xf
v_add_f32_dpp v19, v19, v19 row_ror:8 row_mask:0xf bank_mask:0xf
v_add_f32_dpp v20, v20, v20 row_ror:8 row_mask:0xf bank_mask:0xf
v_add_f32_dpp v21, v21, v21 row_ror:8 row_mask:0xf bank_mask:0xf
v_add_f32_dpp v18, v18, v18 row_ror:4 row_mask:0xf bank_mask:0xf
v_add_f32_dpp v19, v19, v19 row_ror:4 row_mask:0xf bank_mask:0xf
v_add_f32_dpp v20, v20, v20 row_ror:4 row_mask:0xf bank_mask:0xf
v_add_f32_dpp v21, v21, v21 row_ror:4 row_mask:0xf bank_mask:0xf
v_add_f32_dpp v18, v18, v18 row_ror:2 row_mask:0xf bank_mask:0xf
v_add_f32_dpp v19, v19, v19 row_ror:2 row_mask:0xf bank_mask:0xf
v_add_f32_dpp v20, v20, v20 row_ror:2 row_mask:0xf bank_mask:0xf
v_add_f32_dpp v21, v21, v21 row_ror:2 row_mask:0xf bank_mask:0xf
v_add_f32_dpp v18, v18, v18 row_ror:1 row_mask:0xf bank_mask:0xf
v_add_f32_dpp v19, v19, v19 row_ror:1 row_mask:0xf bank_mask:0xf
v_add_f32_dpp v20, v20, v20 row_ror:1 row_mask:0xf bank_mask:0xf
v_add_f32_dpp v21, v21, v21 row_ror:1 row_mask:0xf bank_mask:0xf
v_cvt_pk_bf16_f32 v22, v18, v19
v_cvt_pk_bf16_f32 v23, v20, v21
v_lshlrev_b32 v18, 16, v22
v_and_b32 v19, 0xffff0000, v22
v_lshlrev_b32 v20, 16, v23
v_and_b32 v21, 0xffff0000, v23
v_mul_f32 v18, 0x3db504f3, v18
v_mul_f32 v19, 0x3db504f3, v19
v_mul_f32 v20, 0x3db504f3, v20
v_mul_f32 v21, 0x3db504f3, v21
v_cvt_pk_bf16_f32 v22, v18, v19
v_cvt_pk_bf16_f32 v23, v20, v21
v_lshlrev_b32 v18, 16, v22
v_and_b32 v19, 0xffff0000, v22
v_lshlrev_b32 v20, 16, v23
v_and_b32 v21, 0xffff0000, v23
v_max3_f32 v22, v16, v18, v19
v_max3_f32 v22, v22, v20, v21
v_sub_f32 v23, v16, v22
v_mov_b32 v16, v22
v_mul_f32 v23, s24, v23
v_mul_f32 v22, s24, v22
v_exp_f32 v24, v23
v_fma_f32 v18, v18, s24, -v22
v_fma_f32 v19, v19, s24, -v22
v_fma_f32 v20, v20, s24, -v22
v_fma_f32 v21, v21, s24, -v22
v_exp_f32 v18, v18
v_exp_f32 v19, v19
v_exp_f32 v20, v20
v_exp_f32 v21, v21
v_pk_mul_f32 v[8:9], v[8:9], v[24:25] op_sel_hi:[1,0]
v_pk_mul_f32 v[10:11], v[10:11], v[24:25] op_sel_hi:[1,0]
v_pk_mul_f32 v[12:13], v[12:13], v[24:25] op_sel_hi:[1,0]
v_pk_mul_f32 v[14:15], v[14:15], v[24:25] op_sel_hi:[1,0]
v_fma_f32 v17, v17, v24, v18
v_add_f32 v17, v17, v19
v_add_f32 v17, v17, v20
v_add_f32 v17, v17, v21
s_waitcnt vmcnt(4)
v_lshlrev_b32 v26, 16, v56
v_and_b32 v27, s25, v56
v_lshlrev_b32 v28, 16, v57
v_and_b32 v29, s25, v57
v_lshlrev_b32 v30, 16, v58
v_and_b32 v31, s25, v58
v_lshlrev_b32 v32, 16, v59
v_and_b32 v33, s25, v59
v_pk_fma_f32 v[8:9], v[26:27], v[18:19], v[8:9] op_sel:[0,0,0] op_sel_hi:[1,0,1]
v_pk_fma_f32 v[10:11], v[28:29], v[18:19], v[10:11] op_sel:[0,0,0] op_sel_hi:[1,0,1]
v_pk_fma_f32 v[12:13], v[30:31], v[18:19], v[12:13] op_sel:[0,0,0] op_sel_hi:[1,0,1]
v_pk_fma_f32 v[14:15], v[32:33], v[18:19], v[14:15] op_sel:[0,0,0] op_sel_hi:[1,0,1]
v_lshlrev_b32 v26, 16, v60
v_and_b32 v27, s25, v60
v_lshlrev_b32 v28, 16, v61
v_and_b32 v29, s25, v61
v_lshlrev_b32 v30, 16, v62
v_and_b32 v31, s25, v62
v_lshlrev_b32 v32, 16, v63
v_and_b32 v33, s25, v63
v_pk_fma_f32 v[8:9], v[26:27], v[18:19], v[8:9] op_sel:[0,1,0] op_sel_hi:[1,1,1]
v_pk_fma_f32 v[10:11], v[28:29], v[18:19], v[10:11] op_sel:[0,1,0] op_sel_hi:[1,1,1]
v_pk_fma_f32 v[12:13], v[30:31], v[18:19], v[12:13] op_sel:[0,1,0] op_sel_hi:[1,1,1]
v_pk_fma_f32 v[14:15], v[32:33], v[18:19], v[14:15] op_sel:[0,1,0] op_sel_hi:[1,1,1]
v_lshlrev_b32 v26, 16, v64
v_and_b32 v27, s25, v64
v_lshlrev_b32 v28, 16, v65
v_and_b32 v29, s25, v65
v_lshlrev_b32 v30, 16, v66
v_and_b32 v31, s25, v66
v_lshlrev_b32 v32, 16, v67
v_and_b32 v33, s25, v67
v_pk_fma_f32 v[8:9], v[26:27], v[20:21], v[8:9] op_sel:[0,0,0] op_sel_hi:[1,0,1]
v_pk_fma_f32 v[10:11], v[28:29], v[20:21], v[10:11] op_sel:[0,0,0] op_sel_hi:[1,0,1]
v_pk_fma_f32 v[12:13], v[30:31], v[20:21], v[12:13] op_sel:[0,0,0] op_sel_hi:[1,0,1]
v_pk_fma_f32 v[14:15], v[32:33], v[20:21], v[14:15] op_sel:[0,0,0] op_sel_hi:[1,0,1]
v_lshlrev_b32 v26, 16, v68
v_and_b32 v27, s25, v68
v_lshlrev_b32 v28, 16, v69
v_and_b32 v29, s25, v69
v_lshlrev_b32 v30, 16, v70
v_and_b32 v31, s25, v70
v_lshlrev_b32 v32, 16, v71
v_and_b32 v33, s25, v71
v_pk_fma_f32 v[8:9], v[26:27], v[20:21], v[8:9] op_sel:[0,1,0] op_sel_hi:[1,1,1]
v_pk_fma_f32 v[10:11], v[28:29], v[20:21], v[10:11] op_sel:[0,1,0] op_sel_hi:[1,1,1]
v_pk_fma_f32 v[12:13], v[30:31], v[20:21], v[12:13] op_sel:[0,1,0] op_sel_hi:[1,1,1]
v_pk_fma_f32 v[14:15], v[32:33], v[20:21], v[14:15] op_sel:[0,1,0] op_sel_hi:[1,1,1]
buffer_load_dwordx4 v[56:59], v1, s[12:15], s57 offen offset:0 nt
buffer_load_dwordx4 v[60:63], v1, s[12:15], s57 offen offset:1024 nt
buffer_load_dwordx4 v[64:67], v1, s[12:15], s57 offen offset:2048 nt
buffer_load_dwordx4 v[68:71], v1, s[12:15], s57 offen offset:3072 nt
s_add_u32 s57, s57, 16384
s_waitcnt lgkmcnt(0)
v_dot2_f32_bf16 v18, v72, v4, 0
v_dot2_f32_bf16 v19, v76, v4, 0
v_dot2_f32_bf16 v20, v80, v4, 0
v_dot2_f32_bf16 v21, v84, v4, 0
v_dot2c_f32_bf16 v18, v73, v5
v_dot2c_f32_bf16 v19, v77, v5
v_dot2c_f32_bf16 v20, v81, v5
v_dot2c_f32_bf16 v21, v85, v5
v_dot2c_f32_bf16 v18, v74, v6
v_dot2c_f32_bf16 v19, v78, v6
v_dot2c_f32_bf16 v20, v82, v6
v_dot2c_f32_bf16 v21, v86, v6
v_dot2c_f32_bf16 v18, v75, v7
v_dot2c_f32_bf16 v19, v79, v7
v_dot2c_f32_bf16 v20, v83, v7
v_dot2c_f32_bf16 v21, v87, v7
s_nop 2
v_add_f32_dpp v18, v18, v18 row_ror:8 row_mask:0xf bank_mask:0xf
v_add_f32_dpp v19, v19, v19 row_ror:8 row_mask:0xf bank_mask:0xf
v_add_f32_dpp v20, v20, v20 row_ror:8 row_mask:0xf bank_mask:0xf
v_add_f32_dpp v21, v21, v21 row_ror:8 row_mask:0xf bank_mask:0xf
v_add_f32_dpp v18, v18, v18 row_ror:4 row_mask:0xf bank_mask:0xf
v_add_f32_dpp v19, v19, v19 row_ror:4 row_mask:0xf bank_mask:0xf
v_add_f32_dpp v20, v20, v20 row_ror:4 row_mask:0xf bank_mask:0xf
v_add_f32_dpp v21, v21, v21 row_ror:4 row_mask:0xf bank_mask:0xf
v_add_f32_dpp v18, v18, v18 row_ror:2 row_mask:0xf bank_mask:0xf
v_add_f32_dpp v19, v19, v19 row_ror:2 row_mask:0xf bank_mask:0xf
v_add_f32_dpp v20, v20, v20 row_ror:2 row_mask:0xf bank_mask:0xf
v_add_f32_dpp v21, v21, v21 row_ror:2 row_mask:0xf bank_mask:0xf
v_add_f32_dpp v18, v18, v18 row_ror:1 row_mask:0xf bank_mask:0xf
v_add_f32_dpp v19, v19, v19 row_ror:1 row_mask:0xf bank_mask:0xf
v_add_f32_dpp v20, v20, v20 row_ror:1 row_mask:0xf bank_mask:0xf
v_add_f32_dpp v21, v21, v21 row_ror:1 row_mask:0xf bank_mask:0xf
v_cvt_pk_bf16_f32 v22, v18, v19
v_cvt_pk_bf16_f32 v23, v20, v21
v_lshlrev_b32 v18, 16, v22
v_and_b32 v19, 0xffff0000, v22
v_lshlrev_b32 v20, 16, v23
v_and_b32 v21, 0xffff0000, v23
v_mul_f32 v18, 0x3db504f3, v18
v_mul_f32 v19, 0x3db504f3, v19
v_mul_f32 v20, 0x3db504f3, v20
v_mul_f32 v21, 0x3db504f3, v21
v_cvt_pk_bf16_f32 v22, v18, v19
v_cvt_pk_bf16_f32 v23, v20, v21
v_lshlrev_b32 v18, 16, v22
v_and_b32 v19, 0xffff0000, v22
v_lshlrev_b32 v20, 16, v23
v_and_b32 v21, 0xffff0000, v23
v_max3_f32 v22, v16, v18, v19
v_max3_f32 v22, v22, v20, v21
v_sub_f32 v23, v16, v22
v_mov_b32 v16, v22
v_mul_f32 v23, s24, v23
v_mul_f32 v22, s24, v22
v_exp_f32 v24, v23
v_fma_f32 v18, v18, s24, -v22
v_fma_f32 v19, v19, s24, -v22
v_fma_f32 v20, v20, s24, -v22
v_fma_f32 v21, v21, s24, -v22
v_exp_f32 v18, v18
v_exp_f32 v19, v19
v_exp_f32 v20, v20
v_exp_f32 v21, v21
v_pk_mul_f32 v[8:9], v[8:9], v[24:25] op_sel_hi:[1,0]
v_pk_mul_f32 v[10:11], v[10:11], v[24:25] op_sel_hi:[1,0]
v_pk_mul_f32 v[12:13], v[12:13], v[24:25] op_sel_hi:[1,0]
v_pk_mul_f32 v[14:15], v[14:15], v[24:25] op_sel_hi:[1,0]
v_fma_f32 v17, v17, v24, v18
v_add_f32 v17, v17, v19
v_add_f32 v17, v17, v20
v_add_f32 v17, v17, v21
v_lshlrev_b32 v26, 16, v88
v_and_b32 v27, s25, v88
v_lshlrev_b32 v28, 16, v89
v_and_b32 v29, s25, v89
v_lshlrev_b32 v30, 16, v90
v_and_b32 v31, s25, v90
v_lshlrev_b32 v32, 16, v91
v_and_b32 v33, s25, v91
v_pk_fma_f32 v[8:9], v[26:27], v[18:19], v[8:9] op_sel:[0,0,0] op_sel_hi:[1,0,1]
v_pk_fma_f32 v[10:11], v[28:29], v[18:19], v[10:11] op_sel:[0,0,0] op_sel_hi:[1,0,1]
v_pk_fma_f32 v[12:13], v[30:31], v[18:19], v[12:13] op_sel:[0,0,0] op_sel_hi:[1,0,1]
v_pk_fma_f32 v[14:15], v[32:33], v[18:19], v[14:15] op_sel:[0,0,0] op_sel_hi:[1,0,1]
v_lshlrev_b32 v26, 16, v92
v_and_b32 v27, s25, v92
v_lshlrev_b32 v28, 16, v93
v_and_b32 v29, s25, v93
v_lshlrev_b32 v30, 16, v94
v_and_b32 v31, s25, v94
v_lshlrev_b32 v32, 16, v95
v_and_b32 v33, s25, v95
v_pk_fma_f32 v[8:9], v[26:27], v[18:19], v[8:9] op_sel:[0,1,0] op_sel_hi:[1,1,1]
v_pk_fma_f32 v[10:11], v[28:29], v[18:19], v[10:11] op_sel:[0,1,0] op_sel_hi:[1,1,1]
v_pk_fma_f32 v[12:13], v[30:31], v[18:19], v[12:13] op_sel:[0,1,0] op_sel_hi:[1,1,1]
v_pk_fma_f32 v[14:15], v[32:33], v[18:19], v[14:15] op_sel:[0,1,0] op_sel_hi:[1,1,1]
v_lshlrev_b32 v26, 16, v96
v_and_b32 v27, s25, v96
v_lshlrev_b32 v28, 16, v97
v_and_b32 v29, s25, v97
v_lshlrev_b32 v30, 16, v98
v_and_b32 v31, s25, v98
v_lshlrev_b32 v32, 16, v99
v_and_b32 v33, s25, v99
v_pk_fma_f32 v[8:9], v[26:27], v[20:21], v[8:9] op_sel:[0,0,0] op_sel_hi:[1,0,1]
v_pk_fma_f32 v[10:11], v[28:29], v[20:21], v[10:11] op_sel:[0,0,0] op_sel_hi:[1,0,1]
v_pk_fma_f32 v[12:13], v[30:31], v[20:21], v[12:13] op_sel:[0,0,0] op_sel_hi:[1,0,1]
v_pk_fma_f32 v[14:15], v[32:33], v[20:21], v[14:15] op_sel:[0,0,0] op_sel_hi:[1,0,1]
v_lshlrev_b32 v26, 16, v100
v_and_b32 v27, s25, v100
v_lshlrev_b32 v28, 16, v101
v_and_b32 v29, s25, v101
v_lshlrev_b32 v30, 16, v102
v_and_b32 v31, s25, v102
v_lshlrev_b32 v32, 16, v103
v_and_b32 v33, s25, v103
v_pk_fma_f32 v[8:9], v[26:27], v[20:21], v[8:9] op_sel:[0,1,0] op_sel_hi:[1,1,1]
v_pk_fma_f32 v[10:11], v[28:29], v[20:21], v[10:11] op_sel:[0,1,0] op_sel_hi:[1,1,1]
v_pk_fma_f32 v[12:13], v[30:31], v[20:21], v[12:13] op_sel:[0,1,0] op_sel_hi:[1,1,1]
v_pk_fma_f32 v[14:15], v[32:33], v[20:21], v[14:15] op_sel:[0,1,0] op_sel_hi:[1,1,1]
s_waitcnt vmcnt(4)
ds_read_b128 v[72:75], v39 offset:32768
ds_read_b128 v[76:79], v39 offset:33792
ds_read_b128 v[80:83], v39 offset:34816
ds_read_b128 v[84:87], v39 offset:35840
ds_read_b128 v[88:91], v39 offset:36864
ds_read_b128 v[92:95], v39 offset:37888
ds_read_b128 v[96:99], v39 offset:38912
ds_read_b128 v[100:103], v39 offset:39936
v_dot2_f32_bf16 v18, v40, v4, 0
v_dot2_f32_bf16 v19, v44, v4, 0
v_dot2_f32_bf16 v20, v48, v4, 0
v_dot2_f32_bf16 v21, v52, v4, 0
v_dot2c_f32_bf16 v18, v41, v5
v_dot2c_f32_bf16 v19, v45, v5
v_dot2c_f32_bf16 v20, v49, v5
v_dot2c_f32_bf16 v21, v53, v5
v_dot2c_f32_bf16 v18, v42, v6
v_dot2c_f32_bf16 v19, v46, v6
v_dot2c_f32_bf16 v20, v50, v6
v_dot2c_f32_bf16 v21, v54, v6
v_dot2c_f32_bf16 v18, v43, v7
v_dot2c_f32_bf16 v19, v47, v7
v_dot2c_f32_bf16 v20, v51, v7
v_dot2c_f32_bf16 v21, v55, v7
buffer_load_dwordx4 v[40:43], v1, s[8:11], s57 offen offset:0 nt
buffer_load_dwordx4 v[44:47], v1, s[8:11], s57 offen offset:1024 nt
buffer_load_dwordx4 v[48:51], v1, s[8:11], s57 offen offset:2048 nt
buffer_load_dwordx4 v[52:55], v1, s[8:11], s57 offen offset:3072 nt
v_add_f32_dpp v18, v18, v18 row_ror:8 row_mask:0xf bank_mask:0xf
v_add_f32_dpp v19, v19, v19 row_ror:8 row_mask:0xf bank_mask:0xf
v_add_f32_dpp v20, v20, v20 row_ror:8 row_mask:0xf bank_mask:0xf
v_add_f32_dpp v21, v21, v21 row_ror:8 row_mask:0xf bank_mask:0xf
v_add_f32_dpp v18, v18, v18 row_ror:4 row_mask:0xf bank_mask:0xf
v_add_f32_dpp v19, v19, v19 row_ror:4 row_mask:0xf bank_mask:0xf
v_add_f32_dpp v20, v20, v20 row_ror:4 row_mask:0xf bank_mask:0xf
v_add_f32_dpp v21, v21, v21 row_ror:4 row_mask:0xf bank_mask:0xf
v_add_f32_dpp v18, v18, v18 row_ror:2 row_mask:0xf bank_mask:0xf
v_add_f32_dpp v19, v19, v19 row_ror:2 row_mask:0xf bank_mask:0xf
v_add_f32_dpp v20, v20, v20 row_ror:2 row_mask:0xf bank_mask:0xf
v_add_f32_dpp v21, v21, v21 row_ror:2 row_mask:0xf bank_mask:0xf
v_add_f32_dpp v18, v18, v18 row_ror:1 row_mask:0xf bank_mask:0xf
v_add_f32_dpp v19, v19, v19 row_ror:1 row_mask:0xf bank_mask:0xf
v_add_f32_dpp v20, v20, v20 row_ror:1 row_mask:0xf bank_mask:0xf
v_add_f32_dpp v21, v21, v21 row_ror:1 row_mask:0xf bank_mask:0xf
v_cvt_pk_bf16_f32 v22, v18, v19
v_cvt_pk_bf16_f32 v23, v20, v21
v_lshlrev_b32 v18, 16, v22
v_and_b32 v19, 0xffff0000, v22
v_lshlrev_b32 v20, 16, v23
v_and_b32 v21, 0xffff0000, v23
v_mul_f32 v18, 0x3db504f3, v18
v_mul_f32 v19, 0x3db504f3, v19
v_mul_f32 v20, 0x3db504f3, v20
v_mul_f32 v21, 0x3db504f3, v21
v_cvt_pk_bf16_f32 v22, v18, v19
v_cvt_pk_bf16_f32 v23, v20, v21
v_lshlrev_b32 v18, 16, v22
v_and_b32 v19, 0xffff0000, v22
v_lshlrev_b32 v20, 16, v23
v_and_b32 v21, 0xffff0000, v23
v_max3_f32 v22, v16, v18, v19
v_max3_f32 v22, v22, v20, v21
v_sub_f32 v23, v16, v22
v_mov_b32 v16, v22
v_mul_f32 v23, s24, v23
v_mul_f32 v22, s24, v22
v_exp_f32 v24, v23
v_fma_f32 v18, v18, s24, -v22
v_fma_f32 v19, v19, s24, -v22
v_fma_f32 v20, v20, s24, -v22
v_fma_f32 v21, v21, s24, -v22
v_exp_f32 v18, v18
v_exp_f32 v19, v19
v_exp_f32 v20, v20
v_exp_f32 v21, v21
v_pk_mul_f32 v[8:9], v[8:9], v[24:25] op_sel_hi:[1,0]
v_pk_mul_f32 v[10:11], v[10:11], v[24:25] op_sel_hi:[1,0]
v_pk_mul_f32 v[12:13], v[12:13], v[24:25] op_sel_hi:[1,0]
v_pk_mul_f32 v[14:15], v[14:15], v[24:25] op_sel_hi:[1,0]
v_fma_f32 v17, v17, v24, v18
v_add_f32 v17, v17, v19
v_add_f32 v17, v17, v20
v_add_f32 v17, v17, v21
s_waitcnt vmcnt(4)
v_lshlrev_b32 v26, 16, v56
v_and_b32 v27, s25, v56
v_lshlrev_b32 v28, 16, v57
v_and_b32 v29, s25, v57
v_lshlrev_b32 v30, 16, v58
v_and_b32 v31, s25, v58
v_lshlrev_b32 v32, 16, v59
v_and_b32 v33, s25, v59
v_pk_fma_f32 v[8:9], v[26:27], v[18:19], v[8:9] op_sel:[0,0,0] op_sel_hi:[1,0,1]
v_pk_fma_f32 v[10:11], v[28:29], v[18:19], v[10:11] op_sel:[0,0,0] op_sel_hi:[1,0,1]
v_pk_fma_f32 v[12:13], v[30:31], v[18:19], v[12:13] op_sel:[0,0,0] op_sel_hi:[1,0,1]
v_pk_fma_f32 v[14:15], v[32:33], v[18:19], v[14:15] op_sel:[0,0,0] op_sel_hi:[1,0,1]
v_lshlrev_b32 v26, 16, v60
v_and_b32 v27, s25, v60
v_lshlrev_b32 v28, 16, v61
v_and_b32 v29, s25, v61
v_lshlrev_b32 v30, 16, v62
v_and_b32 v31, s25, v62
v_lshlrev_b32 v32, 16, v63
v_and_b32 v33, s25, v63
v_pk_fma_f32 v[8:9], v[26:27], v[18:19], v[8:9] op_sel:[0,1,0] op_sel_hi:[1,1,1]
v_pk_fma_f32 v[10:11], v[28:29], v[18:19], v[10:11] op_sel:[0,1,0] op_sel_hi:[1,1,1]
v_pk_fma_f32 v[12:13], v[30:31], v[18:19], v[12:13] op_sel:[0,1,0] op_sel_hi:[1,1,1]
v_pk_fma_f32 v[14:15], v[32:33], v[18:19], v[14:15] op_sel:[0,1,0] op_sel_hi:[1,1,1]
v_lshlrev_b32 v26, 16, v64
v_and_b32 v27, s25, v64
v_lshlrev_b32 v28, 16, v65
v_and_b32 v29, s25, v65
v_lshlrev_b32 v30, 16, v66
v_and_b32 v31, s25, v66
v_lshlrev_b32 v32, 16, v67
v_and_b32 v33, s25, v67
v_pk_fma_f32 v[8:9], v[26:27], v[20:21], v[8:9] op_sel:[0,0,0] op_sel_hi:[1,0,1]
v_pk_fma_f32 v[10:11], v[28:29], v[20:21], v[10:11] op_sel:[0,0,0] op_sel_hi:[1,0,1]
v_pk_fma_f32 v[12:13], v[30:31], v[20:21], v[12:13] op_sel:[0,0,0] op_sel_hi:[1,0,1]
v_pk_fma_f32 v[14:15], v[32:33], v[20:21], v[14:15] op_sel:[0,0,0] op_sel_hi:[1,0,1]
v_lshlrev_b32 v26, 16, v68
v_and_b32 v27, s25, v68
v_lshlrev_b32 v28, 16, v69
v_and_b32 v29, s25, v69
v_lshlrev_b32 v30, 16, v70
v_and_b32 v31, s25, v70
v_lshlrev_b32 v32, 16, v71
v_and_b32 v33, s25, v71
v_pk_fma_f32 v[8:9], v[26:27], v[20:21], v[8:9] op_sel:[0,1,0] op_sel_hi:[1,1,1]
v_pk_fma_f32 v[10:11], v[28:29], v[20:21], v[10:11] op_sel:[0,1,0] op_sel_hi:[1,1,1]
v_pk_fma_f32 v[12:13], v[30:31], v[20:21], v[12:13] op_sel:[0,1,0] op_sel_hi:[1,1,1]
v_pk_fma_f32 v[14:15], v[32:33], v[20:21], v[14:15] op_sel:[0,1,0] op_sel_hi:[1,1,1]
buffer_load_dwordx4 v[56:59], v1, s[12:15], s57 offen offset:0 nt
buffer_load_dwordx4 v[60:63], v1, s[12:15], s57 offen offset:1024 nt
buffer_load_dwordx4 v[64:67], v1, s[12:15], s57 offen offset:2048 nt
buffer_load_dwordx4 v[68:71], v1, s[12:15], s57 offen offset:3072 nt
s_add_u32 s57, s57, 16384
s_waitcnt lgkmcnt(0)
v_dot2_f32_bf16 v18, v72, v4, 0
v_dot2_f32_bf16 v19, v76, v4, 0
v_dot2_f32_bf16 v20, v80, v4, 0
v_dot2_f32_bf16 v21, v84, v4, 0
v_dot2c_f32_bf16 v18, v73, v5
v_dot2c_f32_bf16 v19, v77, v5
v_dot2c_f32_bf16 v20, v81, v5
v_dot2c_f32_bf16 v21, v85, v5
v_dot2c_f32_bf16 v18, v74, v6
v_dot2c_f32_bf16 v19, v78, v6
v_dot2c_f32_bf16 v20, v82, v6
v_dot2c_f32_bf16 v21, v86, v6
v_dot2c_f32_bf16 v18, v75, v7
v_dot2c_f32_bf16 v19, v79, v7
v_dot2c_f32_bf16 v20, v83, v7
v_dot2c_f32_bf16 v21, v87, v7
s_nop 2
v_add_f32_dpp v18, v18, v18 row_ror:8 row_mask:0xf bank_mask:0xf
v_add_f32_dpp v19, v19, v19 row_ror:8 row_mask:0xf bank_mask:0xf
v_add_f32_dpp v20, v20, v20 row_ror:8 row_mask:0xf bank_mask:0xf
v_add_f32_dpp v21, v21, v21 row_ror:8 row_mask:0xf bank_mask:0xf
v_add_f32_dpp v18, v18, v18 row_ror:4 row_mask:0xf bank_mask:0xf
v_add_f32_dpp v19, v19, v19 row_ror:4 row_mask:0xf bank_mask:0xf
v_add_f32_dpp v20, v20, v20 row_ror:4 row_mask:0xf bank_mask:0xf
v_add_f32_dpp v21, v21, v21 row_ror:4 row_mask:0xf bank_mask:0xf
v_add_f32_dpp v18, v18, v18 row_ror:2 row_mask:0xf bank_mask:0xf
v_add_f32_dpp v19, v19, v19 row_ror:2 row_mask:0xf bank_mask:0xf
v_add_f32_dpp v20, v20, v20 row_ror:2 row_mask:0xf bank_mask:0xf
v_add_f32_dpp v21, v21, v21 row_ror:2 row_mask:0xf bank_mask:0xf
v_add_f32_dpp v18, v18, v18 row_ror:1 row_mask:0xf bank_mask:0xf
v_add_f32_dpp v19, v19, v19 row_ror:1 row_mask:0xf bank_mask:0xf
v_add_f32_dpp v20, v20, v20 row_ror:1 row_mask:0xf bank_mask:0xf
v_add_f32_dpp v21, v21, v21 row_ror:1 row_mask:0xf bank_mask:0xf
v_cvt_pk_bf16_f32 v22, v18, v19
v_cvt_pk_bf16_f32 v23, v20, v21
v_lshlrev_b32 v18, 16, v22
v_and_b32 v19, 0xffff0000, v22
v_lshlrev_b32 v20, 16, v23
v_and_b32 v21, 0xffff0000, v23
v_mul_f32 v18, 0x3db504f3, v18
v_mul_f32 v19, 0x3db504f3, v19
v_mul_f32 v20, 0x3db504f3, v20
v_mul_f32 v21, 0x3db504f3, v21
v_cvt_pk_bf16_f32 v22, v18, v19
v_cvt_pk_bf16_f32 v23, v20, v21
v_lshlrev_b32 v18, 16, v22
v_and_b32 v19, 0xffff0000, v22
v_lshlrev_b32 v20, 16, v23
v_and_b32 v21, 0xffff0000, v23
v_max3_f32 v22, v16, v18, v19
v_max3_f32 v22, v22, v20, v21
v_sub_f32 v23, v16, v22
v_mov_b32 v16, v22
v_mul_f32 v23, s24, v23
v_mul_f32 v22, s24, v22
v_exp_f32 v24, v23
v_fma_f32 v18, v18, s24, -v22
v_fma_f32 v19, v19, s24, -v22
v_fma_f32 v20, v20, s24, -v22
v_fma_f32 v21, v21, s24, -v22
v_exp_f32 v18, v18
v_exp_f32 v19, v19
v_exp_f32 v20, v20
v_exp_f32 v21, v21
v_pk_mul_f32 v[8:9], v[8:9], v[24:25] op_sel_hi:[1,0]
v_pk_mul_f32 v[10:11], v[10:11], v[24:25] op_sel_hi:[1,0]
v_pk_mul_f32 v[12:13], v[12:13], v[24:25] op_sel_hi:[1,0]
v_pk_mul_f32 v[14:15], v[14:15], v[24:25] op_sel_hi:[1,0]
v_fma_f32 v17, v17, v24, v18
v_add_f32 v17, v17, v19
v_add_f32 v17, v17, v20
v_add_f32 v17, v17, v21
v_lshlrev_b32 v26, 16, v88
v_and_b32 v27, s25, v88
v_lshlrev_b32 v28, 16, v89
v_and_b32 v29, s25, v89
v_lshlrev_b32 v30, 16, v90
v_and_b32 v31, s25, v90
v_lshlrev_b32 v32, 16, v91
v_and_b32 v33, s25, v91
v_pk_fma_f32 v[8:9], v[26:27], v[18:19], v[8:9] op_sel:[0,0,0] op_sel_hi:[1,0,1]
v_pk_fma_f32 v[10:11], v[28:29], v[18:19], v[10:11] op_sel:[0,0,0] op_sel_hi:[1,0,1]
v_pk_fma_f32 v[12:13], v[30:31], v[18:19], v[12:13] op_sel:[0,0,0] op_sel_hi:[1,0,1]
v_pk_fma_f32 v[14:15], v[32:33], v[18:19], v[14:15] op_sel:[0,0,0] op_sel_hi:[1,0,1]
v_lshlrev_b32 v26, 16, v92
v_and_b32 v27, s25, v92
v_lshlrev_b32 v28, 16, v93
v_and_b32 v29, s25, v93
v_lshlrev_b32 v30, 16, v94
v_and_b32 v31, s25, v94
v_lshlrev_b32 v32, 16, v95
v_and_b32 v33, s25, v95
v_pk_fma_f32 v[8:9], v[26:27], v[18:19], v[8:9] op_sel:[0,1,0] op_sel_hi:[1,1,1]
v_pk_fma_f32 v[10:11], v[28:29], v[18:19], v[10:11] op_sel:[0,1,0] op_sel_hi:[1,1,1]
v_pk_fma_f32 v[12:13], v[30:31], v[18:19], v[12:13] op_sel:[0,1,0] op_sel_hi:[1,1,1]
v_pk_fma_f32 v[14:15], v[32:33], v[18:19], v[14:15] op_sel:[0,1,0] op_sel_hi:[1,1,1]
v_lshlrev_b32 v26, 16, v96
v_and_b32 v27, s25, v96
v_lshlrev_b32 v28, 16, v97
v_and_b32 v29, s25, v97
v_lshlrev_b32 v30, 16, v98
v_and_b32 v31, s25, v98
v_lshlrev_b32 v32, 16, v99
v_and_b32 v33, s25, v99
v_pk_fma_f32 v[8:9], v[26:27], v[20:21], v[8:9] op_sel:[0,0,0] op_sel_hi:[1,0,1]
v_pk_fma_f32 v[10:11], v[28:29], v[20:21], v[10:11] op_sel:[0,0,0] op_sel_hi:[1,0,1]
v_pk_fma_f32 v[12:13], v[30:31], v[20:21], v[12:13] op_sel:[0,0,0] op_sel_hi:[1,0,1]
v_pk_fma_f32 v[14:15], v[32:33], v[20:21], v[14:15] op_sel:[0,0,0] op_sel_hi:[1,0,1]
v_lshlrev_b32 v26, 16, v100
v_and_b32 v27, s25, v100
v_lshlrev_b32 v28, 16, v101
v_and_b32 v29, s25, v101
v_lshlrev_b32 v30, 16, v102
v_and_b32 v31, s25, v102
v_lshlrev_b32 v32, 16, v103
v_and_b32 v33, s25, v103
v_pk_fma_f32 v[8:9], v[26:27], v[20:21], v[8:9] op_sel:[0,1,0] op_sel_hi:[1,1,1]
v_pk_fma_f32 v[10:11], v[28:29], v[20:21], v[10:11] op_sel:[0,1,0] op_sel_hi:[1,1,1]
v_pk_fma_f32 v[12:13], v[30:31], v[20:21], v[12:13] op_sel:[0,1,0] op_sel_hi:[1,1,1]
v_pk_fma_f32 v[14:15], v[32:33], v[20:21], v[14:15] op_sel:[0,1,0] op_sel_hi:[1,1,1]
v_add_u32 v39, 0x10000, v39
s_waitcnt vmcnt(4)
ds_read_b128 v[72:75], v39 offset:0
ds_read_b128 v[76:79], v39 offset:1024
ds_read_b128 v[80:83], v39 offset:2048
ds_read_b128 v[84:87], v39 offset:3072
ds_read_b128 v[88:91], v39 offset:4096
ds_read_b128 v[92:95], v39 offset:5120
ds_read_b128 v[96:99], v39 offset:6144
ds_read_b128 v[100:103], v39 offset:7168
v_dot2_f32_bf16 v18, v40, v4, 0
v_dot2_f32_bf16 v19, v44, v4, 0
v_dot2_f32_bf16 v20, v48, v4, 0
v_dot2_f32_bf16 v21, v52, v4, 0
v_dot2c_f32_bf16 v18, v41, v5
v_dot2c_f32_bf16 v19, v45, v5
v_dot2c_f32_bf16 v20, v49, v5
v_dot2c_f32_bf16 v21, v53, v5
v_dot2c_f32_bf16 v18, v42, v6
v_dot2c_f32_bf16 v19, v46, v6
v_dot2c_f32_bf16 v20, v50, v6
v_dot2c_f32_bf16 v21, v54, v6
v_dot2c_f32_bf16 v18, v43, v7
v_dot2c_f32_bf16 v19, v47, v7
v_dot2c_f32_bf16 v20, v51, v7
v_dot2c_f32_bf16 v21, v55, v7
buffer_load_dwordx4 v[40:43], v1, s[8:11], s57 offen offset:0 nt
buffer_load_dwordx4 v[44:47], v1, s[8:11], s57 offen offset:1024 nt
buffer_load_dwordx4 v[48:51], v1, s[8:11], s57 offen offset:2048 nt
buffer_load_dwordx4 v[52:55], v1, s[8:11], s57 offen offset:3072 nt
v_add_f32_dpp v18, v18, v18 row_ror:8 row_mask:0xf bank_mask:0xf
v_add_f32_dpp v19, v19, v19 row_ror:8 row_mask:0xf bank_mask:0xf
v_add_f32_dpp v20, v20, v20 row_ror:8 row_mask:0xf bank_mask:0xf
v_add_f32_dpp v21, v21, v21 row_ror:8 row_mask:0xf bank_mask:0xf
v_add_f32_dpp v18, v18, v18 row_ror:4 row_mask:0xf bank_mask:0xf
v_add_f32_dpp v19, v19, v19 row_ror:4 row_mask:0xf bank_mask:0xf
v_add_f32_dpp v20, v20, v20 row_ror:4 row_mask:0xf bank_mask:0xf
v_add_f32_dpp v21, v21, v21 row_ror:4 row_mask:0xf bank_mask:0xf
v_add_f32_dpp v18, v18, v18 row_ror:2 row_mask:0xf bank_mask:0xf
v_add_f32_dpp v19, v19, v19 row_ror:2 row_mask:0xf bank_mask:0xf
v_add_f32_dpp v20, v20, v20 row_ror:2 row_mask:0xf bank_mask:0xf
v_add_f32_dpp v21, v21, v21 row_ror:2 row_mask:0xf bank_mask:0xf
v_add_f32_dpp v18, v18, v18 row_ror:1 row_mask:0xf bank_mask:0xf
v_add_f32_dpp v19, v19, v19 row_ror:1 row_mask:0xf bank_mask:0xf
v_add_f32_dpp v20, v20, v20 row_ror:1 row_mask:0xf bank_mask:0xf
v_add_f32_dpp v21, v21, v21 row_ror:1 row_mask:0xf bank_mask:0xf
v_cvt_pk_bf16_f32 v22, v18, v19
v_cvt_pk_bf16_f32 v23, v20, v21
v_lshlrev_b32 v18, 16, v22
v_and_b32 v19, 0xffff0000, v22
v_lshlrev_b32 v20, 16, v23
v_and_b32 v21, 0xffff0000, v23
v_mul_f32 v18, 0x3db504f3, v18
v_mul_f32 v19, 0x3db504f3, v19
v_mul_f32 v20, 0x3db504f3, v20
v_mul_f32 v21, 0x3db504f3, v21
v_cvt_pk_bf16_f32 v22, v18, v19
v_cvt_pk_bf16_f32 v23, v20, v21
v_lshlrev_b32 v18, 16, v22
v_and_b32 v19, 0xffff0000, v22
v_lshlrev_b32 v20, 16, v23
v_and_b32 v21, 0xffff0000, v23
v_max3_f32 v22, v16, v18, v19
v_max3_f32 v22, v22, v20, v21
v_sub_f32 v23, v16, v22
v_mov_b32 v16, v22
v_mul_f32 v23, s24, v23
v_mul_f32 v22, s24, v22
v_exp_f32 v24, v23
v_fma_f32 v18, v18, s24, -v22
v_fma_f32 v19, v19, s24, -v22
v_fma_f32 v20, v20, s24, -v22
v_fma_f32 v21, v21, s24, -v22
v_exp_f32 v18, v18
v_exp_f32 v19, v19
v_exp_f32 v20, v20
v_exp_f32 v21, v21
v_pk_mul_f32 v[8:9], v[8:9], v[24:25] op_sel_hi:[1,0]
v_pk_mul_f32 v[10:11], v[10:11], v[24:25] op_sel_hi:[1,0]
v_pk_mul_f32 v[12:13], v[12:13], v[24:25] op_sel_hi:[1,0]
v_pk_mul_f32 v[14:15], v[14:15], v[24:25] op_sel_hi:[1,0]
v_fma_f32 v17, v17, v24, v18
v_add_f32 v17, v17, v19
v_add_f32 v17, v17, v20
v_add_f32 v17, v17, v21
s_waitcnt vmcnt(4)
v_lshlrev_b32 v26, 16, v56
v_and_b32 v27, s25, v56
v_lshlrev_b32 v28, 16, v57
v_and_b32 v29, s25, v57
v_lshlrev_b32 v30, 16, v58
v_and_b32 v31, s25, v58
v_lshlrev_b32 v32, 16, v59
v_and_b32 v33, s25, v59
v_pk_fma_f32 v[8:9], v[26:27], v[18:19], v[8:9] op_sel:[0,0,0] op_sel_hi:[1,0,1]
v_pk_fma_f32 v[10:11], v[28:29], v[18:19], v[10:11] op_sel:[0,0,0] op_sel_hi:[1,0,1]
v_pk_fma_f32 v[12:13], v[30:31], v[18:19], v[12:13] op_sel:[0,0,0] op_sel_hi:[1,0,1]
v_pk_fma_f32 v[14:15], v[32:33], v[18:19], v[14:15] op_sel:[0,0,0] op_sel_hi:[1,0,1]
v_lshlrev_b32 v26, 16, v60
v_and_b32 v27, s25, v60
v_lshlrev_b32 v28, 16, v61
v_and_b32 v29, s25, v61
v_lshlrev_b32 v30, 16, v62
v_and_b32 v31, s25, v62
v_lshlrev_b32 v32, 16, v63
v_and_b32 v33, s25, v63
v_pk_fma_f32 v[8:9], v[26:27], v[18:19], v[8:9] op_sel:[0,1,0] op_sel_hi:[1,1,1]
v_pk_fma_f32 v[10:11], v[28:29], v[18:19], v[10:11] op_sel:[0,1,0] op_sel_hi:[1,1,1]
v_pk_fma_f32 v[12:13], v[30:31], v[18:19], v[12:13] op_sel:[0,1,0] op_sel_hi:[1,1,1]
v_pk_fma_f32 v[14:15], v[32:33], v[18:19], v[14:15] op_sel:[0,1,0] op_sel_hi:[1,1,1]
v_lshlrev_b32 v26, 16, v64
v_and_b32 v27, s25, v64
v_lshlrev_b32 v28, 16, v65
v_and_b32 v29, s25, v65
v_lshlrev_b32 v30, 16, v66
v_and_b32 v31, s25, v66
v_lshlrev_b32 v32, 16, v67
v_and_b32 v33, s25, v67
v_pk_fma_f32 v[8:9], v[26:27], v[20:21], v[8:9] op_sel:[0,0,0] op_sel_hi:[1,0,1]
v_pk_fma_f32 v[10:11], v[28:29], v[20:21], v[10:11] op_sel:[0,0,0] op_sel_hi:[1,0,1]
v_pk_fma_f32 v[12:13], v[30:31], v[20:21], v[12:13] op_sel:[0,0,0] op_sel_hi:[1,0,1]
v_pk_fma_f32 v[14:15], v[32:33], v[20:21], v[14:15] op_sel:[0,0,0] op_sel_hi:[1,0,1]
v_lshlrev_b32 v26, 16, v68
v_and_b32 v27, s25, v68
v_lshlrev_b32 v28, 16, v69
v_and_b32 v29, s25, v69
v_lshlrev_b32 v30, 16, v70
v_and_b32 v31, s25, v70
v_lshlrev_b32 v32, 16, v71
v_and_b32 v33, s25, v71
v_pk_fma_f32 v[8:9], v[26:27], v[20:21], v[8:9] op_sel:[0,1,0] op_sel_hi:[1,1,1]
v_pk_fma_f32 v[10:11], v[28:29], v[20:21], v[10:11] op_sel:[0,1,0] op_sel_hi:[1,1,1]
v_pk_fma_f32 v[12:13], v[30:31], v[20:21], v[12:13] op_sel:[0,1,0] op_sel_hi:[1,1,1]
v_pk_fma_f32 v[14:15], v[32:33], v[20:21], v[14:15] op_sel:[0,1,0] op_sel_hi:[1,1,1]
buffer_load_dwordx4 v[56:59], v1, s[12:15], s57 offen offset:0 nt
buffer_load_dwordx4 v[60:63], v1, s[12:15], s57 offen offset:1024 nt
buffer_load_dwordx4 v[64:67], v1, s[12:15], s57 offen offset:2048 nt
buffer_load_dwordx4 v[68:71], v1, s[12:15], s57 offen offset:3072 nt
s_add_u32 s57, s57, 16384
s_waitcnt lgkmcnt(0)
v_dot2_f32_bf16 v18, v72, v4, 0
v_dot2_f32_bf16 v19, v76, v4, 0
v_dot2_f32_bf16 v20, v80, v4, 0
v_dot2_f32_bf16 v21, v84, v4, 0
v_dot2c_f32_bf16 v18, v73, v5
v_dot2c_f32_bf16 v19, v77, v5
v_dot2c_f32_bf16 v20, v81, v5
v_dot2c_f32_bf16 v21, v85, v5
v_dot2c_f32_bf16 v18, v74, v6
v_dot2c_f32_bf16 v19, v78, v6
v_dot2c_f32_bf16 v20, v82, v6
v_dot2c_f32_bf16 v21, v86, v6
v_dot2c_f32_bf16 v18, v75, v7
v_dot2c_f32_bf16 v19, v79, v7
v_dot2c_f32_bf16 v20, v83, v7
v_dot2c_f32_bf16 v21, v87, v7
s_nop 2
v_add_f32_dpp v18, v18, v18 row_ror:8 row_mask:0xf bank_mask:0xf
v_add_f32_dpp v19, v19, v19 row_ror:8 row_mask:0xf bank_mask:0xf
v_add_f32_dpp v20, v20, v20 row_ror:8 row_mask:0xf bank_mask:0xf
v_add_f32_dpp v21, v21, v21 row_ror:8 row_mask:0xf bank_mask:0xf
v_add_f32_dpp v18, v18, v18 row_ror:4 row_mask:0xf bank_mask:0xf
v_add_f32_dpp v19, v19, v19 row_ror:4 row_mask:0xf bank_mask:0xf
v_add_f32_dpp v20, v20, v20 row_ror:4 row_mask:0xf bank_mask:0xf
v_add_f32_dpp v21, v21, v21 row_ror:4 row_mask:0xf bank_mask:0xf
v_add_f32_dpp v18, v18, v18 row_ror:2 row_mask:0xf bank_mask:0xf
v_add_f32_dpp v19, v19, v19 row_ror:2 row_mask:0xf bank_mask:0xf
v_add_f32_dpp v20, v20, v20 row_ror:2 row_mask:0xf bank_mask:0xf
v_add_f32_dpp v21, v21, v21 row_ror:2 row_mask:0xf bank_mask:0xf
v_add_f32_dpp v18, v18, v18 row_ror:1 row_mask:0xf bank_mask:0xf
v_add_f32_dpp v19, v19, v19 row_ror:1 row_mask:0xf bank_mask:0xf
v_add_f32_dpp v20, v20, v20 row_ror:1 row_mask:0xf bank_mask:0xf
v_add_f32_dpp v21, v21, v21 row_ror:1 row_mask:0xf bank_mask:0xf
v_cvt_pk_bf16_f32 v22, v18, v19
v_cvt_pk_bf16_f32 v23, v20, v21
v_lshlrev_b32 v18, 16, v22
v_and_b32 v19, 0xffff0000, v22
v_lshlrev_b32 v20, 16, v23
v_and_b32 v21, 0xffff0000, v23
v_mul_f32 v18, 0x3db504f3, v18
v_mul_f32 v19, 0x3db504f3, v19
v_mul_f32 v20, 0x3db504f3, v20
v_mul_f32 v21, 0x3db504f3, v21
v_cvt_pk_bf16_f32 v22, v18, v19
v_cvt_pk_bf16_f32 v23, v20, v21
v_lshlrev_b32 v18, 16, v22
v_and_b32 v19, 0xffff0000, v22
v_lshlrev_b32 v20, 16, v23
v_and_b32 v21, 0xffff0000, v23
v_max3_f32 v22, v16, v18, v19
v_max3_f32 v22, v22, v20, v21
v_sub_f32 v23, v16, v22
v_mov_b32 v16, v22
v_mul_f32 v23, s24, v23
v_mul_f32 v22, s24, v22
v_exp_f32 v24, v23
v_fma_f32 v18, v18, s24, -v22
v_fma_f32 v19, v19, s24, -v22
v_fma_f32 v20, v20, s24, -v22
v_fma_f32 v21, v21, s24, -v22
v_exp_f32 v18, v18
v_exp_f32 v19, v19
v_exp_f32 v20, v20
v_exp_f32 v21, v21
v_pk_mul_f32 v[8:9], v[8:9], v[24:25] op_sel_hi:[1,0]
v_pk_mul_f32 v[10:11], v[10:11], v[24:25] op_sel_hi:[1,0]
v_pk_mul_f32 v[12:13], v[12:13], v[24:25] op_sel_hi:[1,0]
v_pk_mul_f32 v[14:15], v[14:15], v[24:25] op_sel_hi:[1,0]
v_fma_f32 v17, v17, v24, v18
v_add_f32 v17, v17, v19
v_add_f32 v17, v17, v20
v_add_f32 v17, v17, v21
v_lshlrev_b32 v26, 16, v88
v_and_b32 v27, s25, v88
v_lshlrev_b32 v28, 16, v89
v_and_b32 v29, s25, v89
v_lshlrev_b32 v30, 16, v90
v_and_b32 v31, s25, v90
v_lshlrev_b32 v32, 16, v91
v_and_b32 v33, s25, v91
v_pk_fma_f32 v[8:9], v[26:27], v[18:19], v[8:9] op_sel:[0,0,0] op_sel_hi:[1,0,1]
v_pk_fma_f32 v[10:11], v[28:29], v[18:19], v[10:11] op_sel:[0,0,0] op_sel_hi:[1,0,1]
v_pk_fma_f32 v[12:13], v[30:31], v[18:19], v[12:13] op_sel:[0,0,0] op_sel_hi:[1,0,1]
v_pk_fma_f32 v[14:15], v[32:33], v[18:19], v[14:15] op_sel:[0,0,0] op_sel_hi:[1,0,1]
v_lshlrev_b32 v26, 16, v92
v_and_b32 v27, s25, v92
v_lshlrev_b32 v28, 16, v93
v_and_b32 v29, s25, v93
v_lshlrev_b32 v30, 16, v94
v_and_b32 v31, s25, v94
v_lshlrev_b32 v32, 16, v95
v_and_b32 v33, s25, v95
v_pk_fma_f32 v[8:9], v[26:27], v[18:19], v[8:9] op_sel:[0,1,0] op_sel_hi:[1,1,1]
v_pk_fma_f32 v[10:11], v[28:29], v[18:19], v[10:11] op_sel:[0,1,0] op_sel_hi:[1,1,1]
v_pk_fma_f32 v[12:13], v[30:31], v[18:19], v[12:13] op_sel:[0,1,0] op_sel_hi:[1,1,1]
v_pk_fma_f32 v[14:15], v[32:33], v[18:19], v[14:15] op_sel:[0,1,0] op_sel_hi:[1,1,1]
v_lshlrev_b32 v26, 16, v96
v_and_b32 v27, s25, v96
v_lshlrev_b32 v28, 16, v97
v_and_b32 v29, s25, v97
v_lshlrev_b32 v30, 16, v98
v_and_b32 v31, s25, v98
v_lshlrev_b32 v32, 16, v99
v_and_b32 v33, s25, v99
v_pk_fma_f32 v[8:9], v[26:27], v[20:21], v[8:9] op_sel:[0,0,0] op_sel_hi:[1,0,1]
v_pk_fma_f32 v[10:11], v[28:29], v[20:21], v[10:11] op_sel:[0,0,0] op_sel_hi:[1,0,1]
v_pk_fma_f32 v[12:13], v[30:31], v[20:21], v[12:13] op_sel:[0,0,0] op_sel_hi:[1,0,1]
v_pk_fma_f32 v[14:15], v[32:33], v[20:21], v[14:15] op_sel:[0,0,0] op_sel_hi:[1,0,1]
v_lshlrev_b32 v26, 16, v100
v_and_b32 v27, s25, v100
v_lshlrev_b32 v28, 16, v101
v_and_b32 v29, s25, v101
v_lshlrev_b32 v30, 16, v102
v_and_b32 v31, s25, v102
v_lshlrev_b32 v32, 16, v103
v_and_b32 v33, s25, v103
v_pk_fma_f32 v[8:9], v[26:27], v[20:21], v[8:9] op_sel:[0,1,0] op_sel_hi:[1,1,1]
v_pk_fma_f32 v[10:11], v[28:29], v[20:21], v[10:11] op_sel:[0,1,0] op_sel_hi:[1,1,1]
v_pk_fma_f32 v[12:13], v[30:31], v[20:21], v[12:13] op_sel:[0,1,0] op_sel_hi:[1,1,1]
v_pk_fma_f32 v[14:15], v[32:33], v[20:21], v[14:15] op_sel:[0,1,0] op_sel_hi:[1,1,1]
s_waitcnt vmcnt(4)
ds_read_b128 v[72:75], v39 offset:32768
ds_read_b128 v[76:79], v39 offset:33792
ds_read_b128 v[80:83], v39 offset:34816
ds_read_b128 v[84:87], v39 offset:35840
ds_read_b128 v[88:91], v39 offset:36864
ds_read_b128 v[92:95], v39 offset:37888
ds_read_b128 v[96:99], v39 offset:38912
ds_read_b128 v[100:103], v39 offset:39936
v_dot2_f32_bf16 v18, v40, v4, 0
v_dot2_f32_bf16 v19, v44, v4, 0
v_dot2_f32_bf16 v20, v48, v4, 0
v_dot2_f32_bf16 v21, v52, v4, 0
v_dot2c_f32_bf16 v18, v41, v5
v_dot2c_f32_bf16 v19, v45, v5
v_dot2c_f32_bf16 v20, v49, v5
v_dot2c_f32_bf16 v21, v53, v5
v_dot2c_f32_bf16 v18, v42, v6
v_dot2c_f32_bf16 v19, v46, v6
v_dot2c_f32_bf16 v20, v50, v6
v_dot2c_f32_bf16 v21, v54, v6
v_dot2c_f32_bf16 v18, v43, v7
v_dot2c_f32_bf16 v19, v47, v7
v_dot2c_f32_bf16 v20, v51, v7
v_dot2c_f32_bf16 v21, v55, v7
buffer_load_dwordx4 v[40:43], v1, s[8:11], s57 offen offset:0 nt
buffer_load_dwordx4 v[44:47], v1, s[8:11], s57 offen offset:1024 nt
buffer_load_dwordx4 v[48:51], v1, s[8:11], s57 offen offset:2048 nt
buffer_load_dwordx4 v[52:55], v1, s[8:11], s57 offen offset:3072 nt
v_add_f32_dpp v18, v18, v18 row_ror:8 row_mask:0xf bank_mask:0xf
v_add_f32_dpp v19, v19, v19 row_ror:8 row_mask:0xf bank_mask:0xf
v_add_f32_dpp v20, v20, v20 row_ror:8 row_mask:0xf bank_mask:0xf
v_add_f32_dpp v21, v21, v21 row_ror:8 row_mask:0xf bank_mask:0xf
v_add_f32_dpp v18, v18, v18 row_ror:4 row_mask:0xf bank_mask:0xf
v_add_f32_dpp v19, v19, v19 row_ror:4 row_mask:0xf bank_mask:0xf
v_add_f32_dpp v20, v20, v20 row_ror:4 row_mask:0xf bank_mask:0xf
v_add_f32_dpp v21, v21, v21 row_ror:4 row_mask:0xf bank_mask:0xf
v_add_f32_dpp v18, v18, v18 row_ror:2 row_mask:0xf bank_mask:0xf
v_add_f32_dpp v19, v19, v19 row_ror:2 row_mask:0xf bank_mask:0xf
v_add_f32_dpp v20, v20, v20 row_ror:2 row_mask:0xf bank_mask:0xf
v_add_f32_dpp v21, v21, v21 row_ror:2 row_mask:0xf bank_mask:0xf
v_add_f32_dpp v18, v18, v18 row_ror:1 row_mask:0xf bank_mask:0xf
v_add_f32_dpp v19, v19, v19 row_ror:1 row_mask:0xf bank_mask:0xf
v_add_f32_dpp v20, v20, v20 row_ror:1 row_mask:0xf bank_mask:0xf
v_add_f32_dpp v21, v21, v21 row_ror:1 row_mask:0xf bank_mask:0xf
v_cvt_pk_bf16_f32 v22, v18, v19
v_cvt_pk_bf16_f32 v23, v20, v21
v_lshlrev_b32 v18, 16, v22
v_and_b32 v19, 0xffff0000, v22
v_lshlrev_b32 v20, 16, v23
v_and_b32 v21, 0xffff0000, v23
v_mul_f32 v18, 0x3db504f3, v18
v_mul_f32 v19, 0x3db504f3, v19
v_mul_f32 v20, 0x3db504f3, v20
v_mul_f32 v21, 0x3db504f3, v21
v_cvt_pk_bf16_f32 v22, v18, v19
v_cvt_pk_bf16_f32 v23, v20, v21
v_lshlrev_b32 v18, 16, v22
v_and_b32 v19, 0xffff0000, v22
v_lshlrev_b32 v20, 16, v23
v_and_b32 v21, 0xffff0000, v23
v_max3_f32 v22, v16, v18, v19
v_max3_f32 v22, v22, v20, v21
v_sub_f32 v23, v16, v22
v_mov_b32 v16, v22
v_mul_f32 v23, s24, v23
v_mul_f32 v22, s24, v22
v_exp_f32 v24, v23
v_fma_f32 v18, v18, s24, -v22
v_fma_f32 v19, v19, s24, -v22
v_fma_f32 v20, v20, s24, -v22
v_fma_f32 v21, v21, s24, -v22
v_exp_f32 v18, v18
v_exp_f32 v19, v19
v_exp_f32 v20, v20
v_exp_f32 v21, v21
v_pk_mul_f32 v[8:9], v[8:9], v[24:25] op_sel_hi:[1,0]
v_pk_mul_f32 v[10:11], v[10:11], v[24:25] op_sel_hi:[1,0]
v_pk_mul_f32 v[12:13], v[12:13], v[24:25] op_sel_hi:[1,0]
v_pk_mul_f32 v[14:15], v[14:15], v[24:25] op_sel_hi:[1,0]
v_fma_f32 v17, v17, v24, v18
v_add_f32 v17, v17, v19
v_add_f32 v17, v17, v20
v_add_f32 v17, v17, v21
s_waitcnt vmcnt(4)
v_lshlrev_b32 v26, 16, v56
v_and_b32 v27, s25, v56
v_lshlrev_b32 v28, 16, v57
v_and_b32 v29, s25, v57
v_lshlrev_b32 v30, 16, v58
v_and_b32 v31, s25, v58
v_lshlrev_b32 v32, 16, v59
v_and_b32 v33, s25, v59
v_pk_fma_f32 v[8:9], v[26:27], v[18:19], v[8:9] op_sel:[0,0,0] op_sel_hi:[1,0,1]
v_pk_fma_f32 v[10:11], v[28:29], v[18:19], v[10:11] op_sel:[0,0,0] op_sel_hi:[1,0,1]
v_pk_fma_f32 v[12:13], v[30:31], v[18:19], v[12:13] op_sel:[0,0,0] op_sel_hi:[1,0,1]
v_pk_fma_f32 v[14:15], v[32:33], v[18:19], v[14:15] op_sel:[0,0,0] op_sel_hi:[1,0,1]
v_lshlrev_b32 v26, 16, v60
v_and_b32 v27, s25, v60
v_lshlrev_b32 v28, 16, v61
v_and_b32 v29, s25, v61
v_lshlrev_b32 v30, 16, v62
v_and_b32 v31, s25, v62
v_lshlrev_b32 v32, 16, v63
v_and_b32 v33, s25, v63
v_pk_fma_f32 v[8:9], v[26:27], v[18:19], v[8:9] op_sel:[0,1,0] op_sel_hi:[1,1,1]
v_pk_fma_f32 v[10:11], v[28:29], v[18:19], v[10:11] op_sel:[0,1,0] op_sel_hi:[1,1,1]
v_pk_fma_f32 v[12:13], v[30:31], v[18:19], v[12:13] op_sel:[0,1,0] op_sel_hi:[1,1,1]
v_pk_fma_f32 v[14:15], v[32:33], v[18:19], v[14:15] op_sel:[0,1,0] op_sel_hi:[1,1,1]
v_lshlrev_b32 v26, 16, v64
v_and_b32 v27, s25, v64
v_lshlrev_b32 v28, 16, v65
v_and_b32 v29, s25, v65
v_lshlrev_b32 v30, 16, v66
v_and_b32 v31, s25, v66
v_lshlrev_b32 v32, 16, v67
v_and_b32 v33, s25, v67
v_pk_fma_f32 v[8:9], v[26:27], v[20:21], v[8:9] op_sel:[0,0,0] op_sel_hi:[1,0,1]
v_pk_fma_f32 v[10:11], v[28:29], v[20:21], v[10:11] op_sel:[0,0,0] op_sel_hi:[1,0,1]
v_pk_fma_f32 v[12:13], v[30:31], v[20:21], v[12:13] op_sel:[0,0,0] op_sel_hi:[1,0,1]
v_pk_fma_f32 v[14:15], v[32:33], v[20:21], v[14:15] op_sel:[0,0,0] op_sel_hi:[1,0,1]
v_lshlrev_b32 v26, 16, v68
v_and_b32 v27, s25, v68
v_lshlrev_b32 v28, 16, v69
v_and_b32 v29, s25, v69
v_lshlrev_b32 v30, 16, v70
v_and_b32 v31, s25, v70
v_lshlrev_b32 v32, 16, v71
v_and_b32 v33, s25, v71
v_pk_fma_f32 v[8:9], v[26:27], v[20:21], v[8:9] op_sel:[0,1,0] op_sel_hi:[1,1,1]
v_pk_fma_f32 v[10:11], v[28:29], v[20:21], v[10:11] op_sel:[0,1,0] op_sel_hi:[1,1,1]
v_pk_fma_f32 v[12:13], v[30:31], v[20:21], v[12:13] op_sel:[0,1,0] op_sel_hi:[1,1,1]
v_pk_fma_f32 v[14:15], v[32:33], v[20:21], v[14:15] op_sel:[0,1,0] op_sel_hi:[1,1,1]
buffer_load_dwordx4 v[56:59], v1, s[12:15], s57 offen offset:0 nt
buffer_load_dwordx4 v[60:63], v1, s[12:15], s57 offen offset:1024 nt
buffer_load_dwordx4 v[64:67], v1, s[12:15], s57 offen offset:2048 nt
buffer_load_dwordx4 v[68:71], v1, s[12:15], s57 offen offset:3072 nt
s_add_u32 s57, s57, 16384
s_waitcnt lgkmcnt(0)
v_dot2_f32_bf16 v18, v72, v4, 0
v_dot2_f32_bf16 v19, v76, v4, 0
v_dot2_f32_bf16 v20, v80, v4, 0
v_dot2_f32_bf16 v21, v84, v4, 0
v_dot2c_f32_bf16 v18, v73, v5
v_dot2c_f32_bf16 v19, v77, v5
v_dot2c_f32_bf16 v20, v81, v5
v_dot2c_f32_bf16 v21, v85, v5
v_dot2c_f32_bf16 v18, v74, v6
v_dot2c_f32_bf16 v19, v78, v6
v_dot2c_f32_bf16 v20, v82, v6
v_dot2c_f32_bf16 v21, v86, v6
v_dot2c_f32_bf16 v18, v75, v7
v_dot2c_f32_bf16 v19, v79, v7
v_dot2c_f32_bf16 v20, v83, v7
v_dot2c_f32_bf16 v21, v87, v7
s_nop 2
v_add_f32_dpp v18, v18, v18 row_ror:8 row_mask:0xf bank_mask:0xf
v_add_f32_dpp v19, v19, v19 row_ror:8 row_mask:0xf bank_mask:0xf
v_add_f32_dpp v20, v20, v20 row_ror:8 row_mask:0xf bank_mask:0xf
v_add_f32_dpp v21, v21, v21 row_ror:8 row_mask:0xf bank_mask:0xf
v_add_f32_dpp v18, v18, v18 row_ror:4 row_mask:0xf bank_mask:0xf
v_add_f32_dpp v19, v19, v19 row_ror:4 row_mask:0xf bank_mask:0xf
v_add_f32_dpp v20, v20, v20 row_ror:4 row_mask:0xf bank_mask:0xf
v_add_f32_dpp v21, v21, v21 row_ror:4 row_mask:0xf bank_mask:0xf
v_add_f32_dpp v18, v18, v18 row_ror:2 row_mask:0xf bank_mask:0xf
v_add_f32_dpp v19, v19, v19 row_ror:2 row_mask:0xf bank_mask:0xf
v_add_f32_dpp v20, v20, v20 row_ror:2 row_mask:0xf bank_mask:0xf
v_add_f32_dpp v21, v21, v21 row_ror:2 row_mask:0xf bank_mask:0xf
v_add_f32_dpp v18, v18, v18 row_ror:1 row_mask:0xf bank_mask:0xf
v_add_f32_dpp v19, v19, v19 row_ror:1 row_mask:0xf bank_mask:0xf
v_add_f32_dpp v20, v20, v20 row_ror:1 row_mask:0xf bank_mask:0xf
v_add_f32_dpp v21, v21, v21 row_ror:1 row_mask:0xf bank_mask:0xf
v_cvt_pk_bf16_f32 v22, v18, v19
v_cvt_pk_bf16_f32 v23, v20, v21
v_lshlrev_b32 v18, 16, v22
v_and_b32 v19, 0xffff0000, v22
v_lshlrev_b32 v20, 16, v23
v_and_b32 v21, 0xffff0000, v23
v_mul_f32 v18, 0x3db504f3, v18
v_mul_f32 v19, 0x3db504f3, v19
v_mul_f32 v20, 0x3db504f3, v20
v_mul_f32 v21, 0x3db504f3, v21
v_cvt_pk_bf16_f32 v22, v18, v19
v_cvt_pk_bf16_f32 v23, v20, v21
v_lshlrev_b32 v18, 16, v22
v_and_b32 v19, 0xffff0000, v22
v_lshlrev_b32 v20, 16, v23
v_and_b32 v21, 0xffff0000, v23
v_max3_f32 v22, v16, v18, v19
v_max3_f32 v22, v22, v20, v21
v_sub_f32 v23, v16, v22
v_mov_b32 v16, v22
v_mul_f32 v23, s24, v23
v_mul_f32 v22, s24, v22
v_exp_f32 v24, v23
v_fma_f32 v18, v18, s24, -v22
v_fma_f32 v19, v19, s24, -v22
v_fma_f32 v20, v20, s24, -v22
v_fma_f32 v21, v21, s24, -v22
v_exp_f32 v18, v18
v_exp_f32 v19, v19
v_exp_f32 v20, v20
v_exp_f32 v21, v21
v_pk_mul_f32 v[8:9], v[8:9], v[24:25] op_sel_hi:[1,0]
v_pk_mul_f32 v[10:11], v[10:11], v[24:25] op_sel_hi:[1,0]
v_pk_mul_f32 v[12:13], v[12:13], v[24:25] op_sel_hi:[1,0]
v_pk_mul_f32 v[14:15], v[14:15], v[24:25] op_sel_hi:[1,0]
v_fma_f32 v17, v17, v24, v18
v_add_f32 v17, v17, v19
v_add_f32 v17, v17, v20
v_add_f32 v17, v17, v21
v_lshlrev_b32 v26, 16, v88
v_and_b32 v27, s25, v88
v_lshlrev_b32 v28, 16, v89
v_and_b32 v29, s25, v89
v_lshlrev_b32 v30, 16, v90
v_and_b32 v31, s25, v90
v_lshlrev_b32 v32, 16, v91
v_and_b32 v33, s25, v91
v_pk_fma_f32 v[8:9], v[26:27], v[18:19], v[8:9] op_sel:[0,0,0] op_sel_hi:[1,0,1]
v_pk_fma_f32 v[10:11], v[28:29], v[18:19], v[10:11] op_sel:[0,0,0] op_sel_hi:[1,0,1]
v_pk_fma_f32 v[12:13], v[30:31], v[18:19], v[12:13] op_sel:[0,0,0] op_sel_hi:[1,0,1]
v_pk_fma_f32 v[14:15], v[32:33], v[18:19], v[14:15] op_sel:[0,0,0] op_sel_hi:[1,0,1]
v_lshlrev_b32 v26, 16, v92
v_and_b32 v27, s25, v92
v_lshlrev_b32 v28, 16, v93
v_and_b32 v29, s25, v93
v_lshlrev_b32 v30, 16, v94
v_and_b32 v31, s25, v94
v_lshlrev_b32 v32, 16, v95
v_and_b32 v33, s25, v95
v_pk_fma_f32 v[8:9], v[26:27], v[18:19], v[8:9] op_sel:[0,1,0] op_sel_hi:[1,1,1]
v_pk_fma_f32 v[10:11], v[28:29], v[18:19], v[10:11] op_sel:[0,1,0] op_sel_hi:[1,1,1]
v_pk_fma_f32 v[12:13], v[30:31], v[18:19], v[12:13] op_sel:[0,1,0] op_sel_hi:[1,1,1]
v_pk_fma_f32 v[14:15], v[32:33], v[18:19], v[14:15] op_sel:[0,1,0] op_sel_hi:[1,1,1]
v_lshlrev_b32 v26, 16, v96
v_and_b32 v27, s25, v96
v_lshlrev_b32 v28, 16, v97
v_and_b32 v29, s25, v97
v_lshlrev_b32 v30, 16, v98
v_and_b32 v31, s25, v98
v_lshlrev_b32 v32, 16, v99
v_and_b32 v33, s25, v99
v_pk_fma_f32 v[8:9], v[26:27], v[20:21], v[8:9] op_sel:[0,0,0] op_sel_hi:[1,0,1]
v_pk_fma_f32 v[10:11], v[28:29], v[20:21], v[10:11] op_sel:[0,0,0] op_sel_hi:[1,0,1]
v_pk_fma_f32 v[12:13], v[30:31], v[20:21], v[12:13] op_sel:[0,0,0] op_sel_hi:[1,0,1]
v_pk_fma_f32 v[14:15], v[32:33], v[20:21], v[14:15] op_sel:[0,0,0] op_sel_hi:[1,0,1]
v_lshlrev_b32 v26, 16, v100
v_and_b32 v27, s25, v100
v_lshlrev_b32 v28, 16, v101
v_and_b32 v29, s25, v101
v_lshlrev_b32 v30, 16, v102
v_and_b32 v31, s25, v102
v_lshlrev_b32 v32, 16, v103
v_and_b32 v33, s25, v103
v_pk_fma_f32 v[8:9], v[26:27], v[20:21], v[8:9] op_sel:[0,1,0] op_sel_hi:[1,1,1]
v_pk_fma_f32 v[10:11], v[28:29], v[20:21], v[10:11] op_sel:[0,1,0] op_sel_hi:[1,1,1]
v_pk_fma_f32 v[12:13], v[30:31], v[20:21], v[12:13] op_sel:[0,1,0] op_sel_hi:[1,1,1]
v_pk_fma_f32 v[14:15], v[32:33], v[20:21], v[14:15] op_sel:[0,1,0] op_sel_hi:[1,1,1]
s_mov_b32 s26, 32
L_A:
s_waitcnt vmcnt(4)
v_dot2_f32_bf16 v18, v40, v4, 0
v_dot2_f32_bf16 v19, v44, v4, 0
v_dot2_f32_bf16 v20, v48, v4, 0
v_dot2_f32_bf16 v21, v52, v4, 0
v_dot2c_f32_bf16 v18, v41, v5
v_dot2c_f32_bf16 v19, v45, v5
v_dot2c_f32_bf16 v20, v49, v5
v_dot2c_f32_bf16 v21, v53, v5
v_dot2c_f32_bf16 v18, v42, v6
v_dot2c_f32_bf16 v19, v46, v6
v_dot2c_f32_bf16 v20, v50, v6
v_dot2c_f32_bf16 v21, v54, v6
v_dot2c_f32_bf16 v18, v43, v7
v_dot2c_f32_bf16 v19, v47, v7
v_dot2c_f32_bf16 v20, v51, v7
v_dot2c_f32_bf16 v21, v55, v7
buffer_load_dwordx4 v[40:43], v1, s[8:11], s57 offen offset:0 nt
buffer_load_dwordx4 v[44:47], v1, s[8:11], s57 offen offset:1024 nt
buffer_load_dwordx4 v[48:51], v1, s[8:11], s57 offen offset:2048 nt
buffer_load_dwordx4 v[52:55], v1, s[8:11], s57 offen offset:3072 nt
v_add_f32_dpp v18, v18, v18 row_ror:8 row_mask:0xf bank_mask:0xf
v_add_f32_dpp v19, v19, v19 row_ror:8 row_mask:0xf bank_mask:0xf
v_add_f32_dpp v20, v20, v20 row_ror:8 row_mask:0xf bank_mask:0xf
v_add_f32_dpp v21, v21, v21 row_ror:8 row_mask:0xf bank_mask:0xf
v_add_f32_dpp v18, v18, v18 row_ror:4 row_mask:0xf bank_mask:0xf
v_add_f32_dpp v19, v19, v19 row_ror:4 row_mask:0xf bank_mask:0xf
v_add_f32_dpp v20, v20, v20 row_ror:4 row_mask:0xf bank_mask:0xf
v_add_f32_dpp v21, v21, v21 row_ror:4 row_mask:0xf bank_mask:0xf
v_add_f32_dpp v18, v18, v18 row_ror:2 row_mask:0xf bank_mask:0xf
v_add_f32_dpp v19, v19, v19 row_ror:2 row_mask:0xf bank_mask:0xf
v_add_f32_dpp v20, v20, v20 row_ror:2 row_mask:0xf bank_mask:0xf
v_add_f32_dpp v21, v21, v21 row_ror:2 row_mask:0xf bank_mask:0xf
v_add_f32_dpp v18, v18, v18 row_ror:1 row_mask:0xf bank_mask:0xf
v_add_f32_dpp v19, v19, v19 row_ror:1 row_mask:0xf bank_mask:0xf
v_add_f32_dpp v20, v20, v20 row_ror:1 row_mask:0xf bank_mask:0xf
v_add_f32_dpp v21, v21, v21 row_ror:1 row_mask:0xf bank_mask:0xf
v_cvt_pk_bf16_f32 v22, v18, v19
v_cvt_pk_bf16_f32 v23, v20, v21
v_lshlrev_b32 v18, 16, v22
v_and_b32 v19, 0xffff0000, v22
v_lshlrev_b32 v20, 16, v23
v_and_b32 v21, 0xffff0000, v23
v_mul_f32 v18, 0x3db504f3, v18
v_mul_f32 v19, 0x3db504f3, v19
v_mul_f32 v20, 0x3db504f3, v20
v_mul_f32 v21, 0x3db504f3, v21
v_cvt_pk_bf16_f32 v22, v18, v19
v_cvt_pk_bf16_f32 v23, v20, v21
v_lshlrev_b32 v18, 16, v22
v_and_b32 v19, 0xffff0000, v22
v_lshlrev_b32 v20, 16, v23
v_and_b32 v21, 0xffff0000, v23
v_max3_f32 v22, v16, v18, v19
v_max3_f32 v22, v22, v20, v21
v_sub_f32 v23, v16, v22
v_mov_b32 v16, v22
v_mul_f32 v23, s24, v23
v_mul_f32 v22, s24, v22
v_exp_f32 v24, v23
v_fma_f32 v18, v18, s24, -v22
v_fma_f32 v19, v19, s24, -v22
v_fma_f32 v20, v20, s24, -v22
v_fma_f32 v21, v21, s24, -v22
v_exp_f32 v18, v18
v_exp_f32 v19, v19
v_exp_f32 v20, v20
v_exp_f32 v21, v21
v_pk_mul_f32 v[8:9], v[8:9], v[24:25] op_sel_hi:[1,0]
v_pk_mul_f32 v[10:11], v[10:11], v[24:25] op_sel_hi:[1,0]
v_pk_mul_f32 v[12:13], v[12:13], v[24:25] op_sel_hi:[1,0]
v_pk_mul_f32 v[14:15], v[14:15], v[24:25] op_sel_hi:[1,0]
v_fma_f32 v17, v17, v24, v18
v_add_f32 v17, v17, v19
v_add_f32 v17, v17, v20
v_add_f32 v17, v17, v21
s_waitcnt vmcnt(4)
v_lshlrev_b32 v26, 16, v56
v_and_b32 v27, s25, v56
v_lshlrev_b32 v28, 16, v57
v_and_b32 v29, s25, v57
v_lshlrev_b32 v30, 16, v58
v_and_b32 v31, s25, v58
v_lshlrev_b32 v32, 16, v59
v_and_b32 v33, s25, v59
v_pk_fma_f32 v[8:9], v[26:27], v[18:19], v[8:9] op_sel:[0,0,0] op_sel_hi:[1,0,1]
v_pk_fma_f32 v[10:11], v[28:29], v[18:19], v[10:11] op_sel:[0,0,0] op_sel_hi:[1,0,1]
v_pk_fma_f32 v[12:13], v[30:31], v[18:19], v[12:13] op_sel:[0,0,0] op_sel_hi:[1,0,1]
v_pk_fma_f32 v[14:15], v[32:33], v[18:19], v[14:15] op_sel:[0,0,0] op_sel_hi:[1,0,1]
v_lshlrev_b32 v26, 16, v60
v_and_b32 v27, s25, v60
v_lshlrev_b32 v28, 16, v61
v_and_b32 v29, s25, v61
v_lshlrev_b32 v30, 16, v62
v_and_b32 v31, s25, v62
v_lshlrev_b32 v32, 16, v63
v_and_b32 v33, s25, v63
v_pk_fma_f32 v[8:9], v[26:27], v[18:19], v[8:9] op_sel:[0,1,0] op_sel_hi:[1,1,1]
v_pk_fma_f32 v[10:11], v[28:29], v[18:19], v[10:11] op_sel:[0,1,0] op_sel_hi:[1,1,1]
v_pk_fma_f32 v[12:13], v[30:31], v[18:19], v[12:13] op_sel:[0,1,0] op_sel_hi:[1,1,1]
v_pk_fma_f32 v[14:15], v[32:33], v[18:19], v[14:15] op_sel:[0,1,0] op_sel_hi:[1,1,1]
v_lshlrev_b32 v26, 16, v64
v_and_b32 v27, s25, v64
v_lshlrev_b32 v28, 16, v65
v_and_b32 v29, s25, v65
v_lshlrev_b32 v30, 16, v66
v_and_b32 v31, s25, v66
v_lshlrev_b32 v32, 16, v67
v_and_b32 v33, s25, v67
v_pk_fma_f32 v[8:9], v[26:27], v[20:21], v[8:9] op_sel:[0,0,0] op_sel_hi:[1,0,1]
v_pk_fma_f32 v[10:11], v[28:29], v[20:21], v[10:11] op_sel:[0,0,0] op_sel_hi:[1,0,1]
v_pk_fma_f32 v[12:13], v[30:31], v[20:21], v[12:13] op_sel:[0,0,0] op_sel_hi:[1,0,1]
v_pk_fma_f32 v[14:15], v[32:33], v[20:21], v[14:15] op_sel:[0,0,0] op_sel_hi:[1,0,1]
v_lshlrev_b32 v26, 16, v68
v_and_b32 v27, s25, v68
v_lshlrev_b32 v28, 16, v69
v_and_b32 v29, s25, v69
v_lshlrev_b32 v30, 16, v70
v_and_b32 v31, s25, v70
v_lshlrev_b32 v32, 16, v71
v_and_b32 v33, s25, v71
v_pk_fma_f32 v[8:9], v[26:27], v[20:21], v[8:9] op_sel:[0,1,0] op_sel_hi:[1,1,1]
v_pk_fma_f32 v[10:11], v[28:29], v[20:21], v[10:11] op_sel:[0,1,0] op_sel_hi:[1,1,1]
v_pk_fma_f32 v[12:13], v[30:31], v[20:21], v[12:13] op_sel:[0,1,0] op_sel_hi:[1,1,1]
v_pk_fma_f32 v[14:15], v[32:33], v[20:21], v[14:15] op_sel:[0,1,0] op_sel_hi:[1,1,1]
buffer_load_dwordx4 v[56:59], v1, s[12:15], s57 offen offset:0 nt
buffer_load_dwordx4 v[60:63], v1, s[12:15], s57 offen offset:1024 nt
buffer_load_dwordx4 v[64:67], v1, s[12:15], s57 offen offset:2048 nt
buffer_load_dwordx4 v[68:71], v1, s[12:15], s57 offen offset:3072 nt
s_add_u32 s57, s57, 16384
s_sub_u32 s26, s26, 1
s_cmp_lg_u32 s26, 0
s_cbranch_scc1 L_A
s_mov_b32 s26, 1
L_A2:
s_waitcnt vmcnt(4)
v_dot2_f32_bf16 v18, v40, v4, 0
v_dot2_f32_bf16 v19, v44, v4, 0
v_dot2_f32_bf16 v20, v48, v4, 0
v_dot2_f32_bf16 v21, v52, v4, 0
v_dot2c_f32_bf16 v18, v41, v5
v_dot2c_f32_bf16 v19, v45, v5
v_dot2c_f32_bf16 v20, v49, v5
v_dot2c_f32_bf16 v21, v53, v5
v_dot2c_f32_bf16 v18, v42, v6
v_dot2c_f32_bf16 v19, v46, v6
v_dot2c_f32_bf16 v20, v50, v6
v_dot2c_f32_bf16 v21, v54, v6
v_dot2c_f32_bf16 v18, v43, v7
v_dot2c_f32_bf16 v19, v47, v7
v_dot2c_f32_bf16 v20, v51, v7
v_dot2c_f32_bf16 v21, v55, v7
ds_max_u32 v2, v37 offset:1536
v_add_u32 v37, 1, v37
buffer_load_dwordx4 v[40:43], v1, s[8:11], s57 offen offset:0 nt
buffer_load_dwordx4 v[44:47], v1, s[8:11], s57 offen offset:1024 nt
buffer_load_dwordx4 v[48:51], v1, s[8:11], s57 offen offset:2048 nt
buffer_load_dwordx4 v[52:55], v1, s[8:11], s57 offen offset:3072 nt
v_add_f32_dpp v18, v18, v18 row_ror:8 row_mask:0xf bank_mask:0xf
v_add_f32_dpp v19, v19, v19 row_ror:8 row_mask:0xf bank_mask:0xf
v_add_f32_dpp v20, v20, v20 row_ror:8 row_mask:0xf bank_mask:0xf
v_add_f32_dpp v21, v21, v21 row_ror:8 row_mask:0xf bank_mask:0xf
v_add_f32_dpp v18, v18, v18 row_ror:4 row_mask:0xf bank_mask:0xf
v_add_f32_dpp v19, v19, v19 row_ror:4 row_mask:0xf bank_mask:0xf
v_add_f32_dpp v20, v20, v20 row_ror:4 row_mask:0xf bank_mask:0xf
v_add_f32_dpp v21, v21, v21 row_ror:4 row_mask:0xf bank_mask:0xf
v_add_f32_dpp v18, v18, v18 row_ror:2 row_mask:0xf bank_mask:0xf
v_add_f32_dpp v19, v19, v19 row_ror:2 row_mask:0xf bank_mask:0xf
v_add_f32_dpp v20, v20, v20 row_ror:2 row_mask:0xf bank_mask:0xf
v_add_f32_dpp v21, v21, v21 row_ror:2 row_mask:0xf bank_mask:0xf
v_add_f32_dpp v18, v18, v18 row_ror:1 row_mask:0xf bank_mask:0xf
v_add_f32_dpp v19, v19, v19 row_ror:1 row_mask:0xf bank_mask:0xf
v_add_f32_dpp v20, v20, v20 row_ror:1 row_mask:0xf bank_mask:0xf
v_add_f32_dpp v21, v21, v21 row_ror:1 row_mask:0xf bank_mask:0xf
v_cvt_pk_bf16_f32 v22, v18, v19
v_cvt_pk_bf16_f32 v23, v20, v21
v_lshlrev_b32 v18, 16, v22
v_and_b32 v19, 0xffff0000, v22
v_lshlrev_b32 v20, 16, v23
v_and_b32 v21, 0xffff0000, v23
v_mul_f32 v18, 0x3db504f3, v18
v_mul_f32 v19, 0x3db504f3, v19
v_mul_f32 v20, 0x3db504f3, v20
v_mul_f32 v21, 0x3db504f3, v21
v_cvt_pk_bf16_f32 v22, v18, v19
v_cvt_pk_bf16_f32 v23, v20, v21
v_lshlrev_b32 v18, 16, v22
v_and_b32 v19, 0xffff0000, v22
v_lshlrev_b32 v20, 16, v23
v_and_b32 v21, 0xffff0000, v23
v_max3_f32 v22, v16, v18, v19
v_max3_f32 v22, v22, v20, v21
v_sub_f32 v23, v16, v22
v_mov_b32 v16, v22
v_mul_f32 v23, s24, v23
v_mul_f32 v22, s24, v22
v_exp_f32 v24, v23
v_fma_f32 v18, v18, s24, -v22
v_fma_f32 v19, v19, s24, -v22
v_fma_f32 v20, v20, s24, -v22
v_fma_f32 v21, v21, s24, -v22
v_exp_f32 v18, v18
v_exp_f32 v19, v19
v_exp_f32 v20, v20
v_exp_f32 v21, v21
v_pk_mul_f32 v[8:9], v[8:9], v[24:25] op_sel_hi:[1,0]
v_pk_mul_f32 v[10:11], v[10:11], v[24:25] op_sel_hi:[1,0]
v_pk_mul_f32 v[12:13], v[12:13], v[24:25] op_sel_hi:[1,0]
v_pk_mul_f32 v[14:15], v[14:15], v[24:25] op_sel_hi:[1,0]
v_fma_f32 v17, v17, v24, v18
v_add_f32 v17, v17, v19
v_add_f32 v17, v17, v20
v_add_f32 v17, v17, v21
s_waitcnt vmcnt(4)
v_lshlrev_b32 v26, 16, v56
v_and_b32 v27, s25, v56
v_lshlrev_b32 v28, 16, v57
v_and_b32 v29, s25, v57
v_lshlrev_b32 v30, 16, v58
v_and_b32 v31, s25, v58
v_lshlrev_b32 v32, 16, v59
v_and_b32 v33, s25, v59
v_pk_fma_f32 v[8:9], v[26:27], v[18:19], v[8:9] op_sel:[0,0,0] op_sel_hi:[1,0,1]
v_pk_fma_f32 v[10:11], v[28:29], v[18:19], v[10:11] op_sel:[0,0,0] op_sel_hi:[1,0,1]
v_pk_fma_f32 v[12:13], v[30:31], v[18:19], v[12:13] op_sel:[0,0,0] op_sel_hi:[1,0,1]
v_pk_fma_f32 v[14:15], v[32:33], v[18:19], v[14:15] op_sel:[0,0,0] op_sel_hi:[1,0,1]
v_lshlrev_b32 v26, 16, v60
v_and_b32 v27, s25, v60
v_lshlrev_b32 v28, 16, v61
v_and_b32 v29, s25, v61
v_lshlrev_b32 v30, 16, v62
v_and_b32 v31, s25, v62
v_lshlrev_b32 v32, 16, v63
v_and_b32 v33, s25, v63
v_pk_fma_f32 v[8:9], v[26:27], v[18:19], v[8:9] op_sel:[0,1,0] op_sel_hi:[1,1,1]
v_pk_fma_f32 v[10:11], v[28:29], v[18:19], v[10:11] op_sel:[0,1,0] op_sel_hi:[1,1,1]
v_pk_fma_f32 v[12:13], v[30:31], v[18:19], v[12:13] op_sel:[0,1,0] op_sel_hi:[1,1,1]
v_pk_fma_f32 v[14:15], v[32:33], v[18:19], v[14:15] op_sel:[0,1,0] op_sel_hi:[1,1,1]
v_lshlrev_b32 v26, 16, v64
v_and_b32 v27, s25, v64
v_lshlrev_b32 v28, 16, v65
v_and_b32 v29, s25, v65
v_lshlrev_b32 v30, 16, v66
v_and_b32 v31, s25, v66
v_lshlrev_b32 v32, 16, v67
v_and_b32 v33, s25, v67
v_pk_fma_f32 v[8:9], v[26:27], v[20:21], v[8:9] op_sel:[0,0,0] op_sel_hi:[1,0,1]
v_pk_fma_f32 v[10:11], v[28:29], v[20:21], v[10:11] op_sel:[0,0,0] op_sel_hi:[1,0,1]
v_pk_fma_f32 v[12:13], v[30:31], v[20:21], v[12:13] op_sel:[0,0,0] op_sel_hi:[1,0,1]
v_pk_fma_f32 v[14:15], v[32:33], v[20:21], v[14:15] op_sel:[0,0,0] op_sel_hi:[1,0,1]
v_lshlrev_b32 v26, 16, v68
v_and_b32 v27, s25, v68
v_lshlrev_b32 v28, 16, v69
v_and_b32 v29, s25, v69
v_lshlrev_b32 v30, 16, v70
v_and_b32 v31, s25, v70
v_lshlrev_b32 v32, 16, v71
v_and_b32 v33, s25, v71
v_pk_fma_f32 v[8:9], v[26:27], v[20:21], v[8:9] op_sel:[0,1,0] op_sel_hi:[1,1,1]
v_pk_fma_f32 v[10:11], v[28:29], v[20:21], v[10:11] op_sel:[0,1,0] op_sel_hi:[1,1,1]
v_pk_fma_f32 v[12:13], v[30:31], v[20:21], v[12:13] op_sel:[0,1,0] op_sel_hi:[1,1,1]
v_pk_fma_f32 v[14:15], v[32:33], v[20:21], v[14:15] op_sel:[0,1,0] op_sel_hi:[1,1,1]
buffer_load_dwordx4 v[56:59], v1, s[12:15], s57 offen offset:0 nt
buffer_load_dwordx4 v[60:63], v1, s[12:15], s57 offen offset:1024 nt
buffer_load_dwordx4 v[64:67], v1, s[12:15], s57 offen offset:2048 nt
buffer_load_dwordx4 v[68:71], v1, s[12:15], s57 offen offset:3072 nt
s_add_u32 s57, s57, 16384
s_sub_u32 s26, s26, 1
s_cmp_lg_u32 s26, 0
s_cbranch_scc1 L_A2
L_B:
s_sub_u32 s79, s79, 1
s_cbranch_scc1 L_end
ds_read_b32 v38, v36 offset:256
s_waitcnt lgkmcnt(0)
v_readfirstlane_b32 s57, v38
s_cmp_eq_u32 s57, -1
s_cbranch_scc1 L_B
s_cmp_ge_u32 s57, 8388608
s_cbranch_scc1 L_Bx
s_add_u32 s57, s57, s56
v_add_u32 v36, 4, v36
s_waitcnt vmcnt(4)
v_dot2_f32_bf16 v18, v40, v4, 0
v_dot2_f32_bf16 v19, v44, v4, 0
v_dot2_f32_bf16 v20, v48, v4, 0
v_dot2_f32_bf16 v21, v52, v4, 0
v_dot2c_f32_bf16 v18, v41, v5
v_dot2c_f32_bf16 v19, v45, v5
v_dot2c_f32_bf16 v20, v49, v5
v_dot2c_f32_bf16 v21, v53, v5
v_dot2c_f32_bf16 v18, v42, v6
v_dot2c_f32_bf16 v19, v46, v6
v_dot2c_f32_bf16 v20, v50, v6
v_dot2c_f32_bf16 v21, v54, v6
v_dot2c_f32_bf16 v18, v43, v7
v_dot2c_f32_bf16 v19, v47, v7
v_dot2c_f32_bf16 v20, v51, v7
v_dot2c_f32_bf16 v21, v55, v7
ds_max_u32 v2, v37 offset:1536
v_add_u32 v37, 1, v37
buffer_load_dwordx4 v[40:43], v1, s[8:11], s57 offen offset:0 nt
buffer_load_dwordx4 v[44:47], v1, s[8:11], s57 offen offset:1024 nt
buffer_load_dwordx4 v[48:51], v1, s[8:11], s57 offen offset:2048 nt
buffer_load_dwordx4 v[52:55], v1, s[8:11], s57 offen offset:3072 nt
v_add_f32_dpp v18, v18, v18 row_ror:8 row_mask:0xf bank_mask:0xf
v_add_f32_dpp v19, v19, v19 row_ror:8 row_mask:0xf bank_mask:0xf
v_add_f32_dpp v20, v20, v20 row_ror:8 row_mask:0xf bank_mask:0xf
v_add_f32_dpp v21, v21, v21 row_ror:8 row_mask:0xf bank_mask:0xf
v_add_f32_dpp v18, v18, v18 row_ror:4 row_mask:0xf bank_mask:0xf
v_add_f32_dpp v19, v19, v19 row_ror:4 row_mask:0xf bank_mask:0xf
v_add_f32_dpp v20, v20, v20 row_ror:4 row_mask:0xf bank_mask:0xf
v_add_f32_dpp v21, v21, v21 row_ror:4 row_mask:0xf bank_mask:0xf
v_add_f32_dpp v18, v18, v18 row_ror:2 row_mask:0xf bank_mask:0xf
v_add_f32_dpp v19, v19, v19 row_ror:2 row_mask:0xf bank_mask:0xf
v_add_f32_dpp v20, v20, v20 row_ror:2 row_mask:0xf bank_mask:0xf
v_add_f32_dpp v21, v21, v21 row_ror:2 row_mask:0xf bank_mask:0xf
v_add_f32_dpp v18, v18, v18 row_ror:1 row_mask:0xf bank_mask:0xf
v_add_f32_dpp v19, v19, v19 row_ror:1 row_mask:0xf bank_mask:0xf
v_add_f32_dpp v20, v20, v20 row_ror:1 row_mask:0xf bank_mask:0xf
v_add_f32_dpp v21, v21, v21 row_ror:1 row_mask:0xf bank_mask:0xf
v_cvt_pk_bf16_f32 v22, v18, v19
v_cvt_pk_bf16_f32 v23, v20, v21
v_lshlrev_b32 v18, 16, v22
v_and_b32 v19, 0xffff0000, v22
v_lshlrev_b32 v20, 16, v23
v_and_b32 v21, 0xffff0000, v23
v_mul_f32 v18, 0x3db504f3, v18
v_mul_f32 v19, 0x3db504f3, v19
v_mul_f32 v20, 0x3db504f3, v20
v_mul_f32 v21, 0x3db504f3, v21
v_cvt_pk_bf16_f32 v22, v18, v19
v_cvt_pk_bf16_f32 v23, v20, v21
v_lshlrev_b32 v18, 16, v22
v_and_b32 v19, 0xffff0000, v22
v_lshlrev_b32 v20, 16, v23
v_and_b32 v21, 0xffff0000, v23
v_max3_f32 v22, v16, v18, v19
v_max3_f32 v22, v22, v20, v21
v_sub_f32 v23, v16, v22
v_mov_b32 v16, v22
v_mul_f32 v23, s24, v23
v_mul_f32 v22, s24, v22
v_exp_f32 v24, v23
v_fma_f32 v18, v18, s24, -v22
v_fma_f32 v19, v19, s24, -v22
v_fma_f32 v20, v20, s24, -v22
v_fma_f32 v21, v21, s24, -v22
v_exp_f32 v18, v18
v_exp_f32 v19, v19
v_exp_f32 v20, v20
v_exp_f32 v21, v21
v_pk_mul_f32 v[8:9], v[8:9], v[24:25] op_sel_hi:[1,0]
v_pk_mul_f32 v[10:11], v[10:11], v[24:25] op_sel_hi:[1,0]
v_pk_mul_f32 v[12:13], v[12:13], v[24:25] op_sel_hi:[1,0]
v_pk_mul_f32 v[14:15], v[14:15], v[24:25] op_sel_hi:[1,0]
v_fma_f32 v17, v17, v24, v18
v_add_f32 v17, v17, v19
v_add_f32 v17, v17, v20
v_add_f32 v17, v17, v21
s_waitcnt vmcnt(4)
v_lshlrev_b32 v26, 16, v56
v_and_b32 v27, s25, v56
v_lshlrev_b32 v28, 16, v57
v_and_b32 v29, s25, v57
v_lshlrev_b32 v30, 16, v58
v_and_b32 v31, s25, v58
v_lshlrev_b32 v32, 16, v59
v_and_b32 v33, s25, v59
v_pk_fma_f32 v[8:9], v[26:27], v[18:19], v[8:9] op_sel:[0,0,0] op_sel_hi:[1,0,1]
v_pk_fma_f32 v[10:11], v[28:29], v[18:19], v[10:11] op_sel:[0,0,0] op_sel_hi:[1,0,1]
v_pk_fma_f32 v[12:13], v[30:31], v[18:19], v[12:13] op_sel:[0,0,0] op_sel_hi:[1,0,1]
v_pk_fma_f32 v[14:15], v[32:33], v[18:19], v[14:15] op_sel:[0,0,0] op_sel_hi:[1,0,1]
v_lshlrev_b32 v26, 16, v60
v_and_b32 v27, s25, v60
v_lshlrev_b32 v28, 16, v61
v_and_b32 v29, s25, v61
v_lshlrev_b32 v30, 16, v62
v_and_b32 v31, s25, v62
v_lshlrev_b32 v32, 16, v63
v_and_b32 v33, s25, v63
v_pk_fma_f32 v[8:9], v[26:27], v[18:19], v[8:9] op_sel:[0,1,0] op_sel_hi:[1,1,1]
v_pk_fma_f32 v[10:11], v[28:29], v[18:19], v[10:11] op_sel:[0,1,0] op_sel_hi:[1,1,1]
v_pk_fma_f32 v[12:13], v[30:31], v[18:19], v[12:13] op_sel:[0,1,0] op_sel_hi:[1,1,1]
v_pk_fma_f32 v[14:15], v[32:33], v[18:19], v[14:15] op_sel:[0,1,0] op_sel_hi:[1,1,1]
v_lshlrev_b32 v26, 16, v64
v_and_b32 v27, s25, v64
v_lshlrev_b32 v28, 16, v65
v_and_b32 v29, s25, v65
v_lshlrev_b32 v30, 16, v66
v_and_b32 v31, s25, v66
v_lshlrev_b32 v32, 16, v67
v_and_b32 v33, s25, v67
v_pk_fma_f32 v[8:9], v[26:27], v[20:21], v[8:9] op_sel:[0,0,0] op_sel_hi:[1,0,1]
v_pk_fma_f32 v[10:11], v[28:29], v[20:21], v[10:11] op_sel:[0,0,0] op_sel_hi:[1,0,1]
v_pk_fma_f32 v[12:13], v[30:31], v[20:21], v[12:13] op_sel:[0,0,0] op_sel_hi:[1,0,1]
v_pk_fma_f32 v[14:15], v[32:33], v[20:21], v[14:15] op_sel:[0,0,0] op_sel_hi:[1,0,1]
v_lshlrev_b32 v26, 16, v68
v_and_b32 v27, s25, v68
v_lshlrev_b32 v28, 16, v69
v_and_b32 v29, s25, v69
v_lshlrev_b32 v30, 16, v70
v_and_b32 v31, s25, v70
v_lshlrev_b32 v32, 16, v71
v_and_b32 v33, s25, v71
v_pk_fma_f32 v[8:9], v[26:27], v[20:21], v[8:9] op_sel:[0,1,0] op_sel_hi:[1,1,1]
v_pk_fma_f32 v[10:11], v[28:29], v[20:21], v[10:11] op_sel:[0,1,0] op_sel_hi:[1,1,1]
v_pk_fma_f32 v[12:13], v[30:31], v[20:21], v[12:13] op_sel:[0,1,0] op_sel_hi:[1,1,1]
v_pk_fma_f32 v[14:15], v[32:33], v[20:21], v[14:15] op_sel:[0,1,0] op_sel_hi:[1,1,1]
buffer_load_dwordx4 v[56:59], v1, s[12:15], s57 offen offset:0 nt
buffer_load_dwordx4 v[60:63], v1, s[12:15], s57 offen offset:1024 nt
buffer_load_dwordx4 v[64:67], v1, s[12:15], s57 offen offset:2048 nt
buffer_load_dwordx4 v[68:71], v1, s[12:15], s57 offen offset:3072 nt
s_add_u32 s57, s57, 16384
s_branch L_B
L_Bx:
L_dry:
s_waitcnt vmcnt(4)
v_dot2_f32_bf16 v18, v40, v4, 0
v_dot2_f32_bf16 v19, v44, v4, 0
v_dot2_f32_bf16 v20, v48, v4, 0
v_dot2_f32_bf16 v21, v52, v4, 0
v_dot2c_f32_bf16 v18, v41, v5
v_dot2c_f32_bf16 v19, v45, v5
v_dot2c_f32_bf16 v20, v49, v5
v_dot2c_f32_bf16 v21, v53, v5
v_dot2c_f32_bf16 v18, v42, v6
v_dot2c_f32_bf16 v19, v46, v6
v_dot2c_f32_bf16 v20, v50, v6
v_dot2c_f32_bf16 v21, v54, v6
v_dot2c_f32_bf16 v18, v43, v7
v_dot2c_f32_bf16 v19, v47, v7
v_dot2c_f32_bf16 v20, v51, v7
v_dot2c_f32_bf16 v21, v55, v7
s_nop 2
v_add_f32_dpp v18, v18, v18 row_ror:8 row_mask:0xf bank_mask:0xf
v_add_f32_dpp v19, v19, v19 row_ror:8 row_mask:0xf bank_mask:0xf
v_add_f32_dpp v20, v20, v20 row_ror:8 row_mask:0xf bank_mask:0xf
v_add_f32_dpp v21, v21, v21 row_ror:8 row_mask:0xf bank_mask:0xf
v_add_f32_dpp v18, v18, v18 row_ror:4 row_mask:0xf bank_mask:0xf
v_add_f32_dpp v19, v19, v19 row_ror:4 row_mask:0xf bank_mask:0xf
v_add_f32_dpp v20, v20, v20 row_ror:4 row_mask:0xf bank_mask:0xf
v_add_f32_dpp v21, v21, v21 row_ror:4 row_mask:0xf bank_mask:0xf
v_add_f32_dpp v18, v18, v18 row_ror:2 row_mask:0xf bank_mask:0xf
v_add_f32_dpp v19, v19, v19 row_ror:2 row_mask:0xf bank_mask:0xf
v_add_f32_dpp v20, v20, v20 row_ror:2 row_mask:0xf bank_mask:0xf
v_add_f32_dpp v21, v21, v21 row_ror:2 row_mask:0xf bank_mask:0xf
v_add_f32_dpp v18, v18, v18 row_ror:1 row_mask:0xf bank_mask:0xf
v_add_f32_dpp v19, v19, v19 row_ror:1 row_mask:0xf bank_mask:0xf
v_add_f32_dpp v20, v20, v20 row_ror:1 row_mask:0xf bank_mask:0xf
v_add_f32_dpp v21, v21, v21 row_ror:1 row_mask:0xf bank_mask:0xf
v_cvt_pk_bf16_f32 v22, v18, v19
v_cvt_pk_bf16_f32 v23, v20, v21
v_lshlrev_b32 v18, 16, v22
v_and_b32 v19, 0xffff0000, v22
v_lshlrev_b32 v20, 16, v23
v_and_b32 v21, 0xffff0000, v23
v_mul_f32 v18, 0x3db504f3, v18
v_mul_f32 v19, 0x3db504f3, v19
v_mul_f32 v20, 0x3db504f3, v20
v_mul_f32 v21, 0x3db504f3, v21
v_cvt_pk_bf16_f32 v22, v18, v19
v_cvt_pk_bf16_f32 v23, v20, v21
v_lshlrev_b32 v18, 16, v22
v_and_b32 v19, 0xffff0000, v22
v_lshlrev_b32 v20, 16, v23
v_and_b32 v21, 0xffff0000, v23
v_max3_f32 v22, v16, v18, v19
v_max3_f32 v22, v22, v20, v21
v_sub_f32 v23, v16, v22
v_mov_b32 v16, v22
v_mul_f32 v23, s24, v23
v_mul_f32 v22, s24, v22
v_exp_f32 v24, v23
v_fma_f32 v18, v18, s24, -v22
v_fma_f32 v19, v19, s24, -v22
v_fma_f32 v20, v20, s24, -v22
v_fma_f32 v21, v21, s24, -v22
v_exp_f32 v18, v18
v_exp_f32 v19, v19
v_exp_f32 v20, v20
v_exp_f32 v21, v21
v_pk_mul_f32 v[8:9], v[8:9], v[24:25] op_sel_hi:[1,0]
v_pk_mul_f32 v[10:11], v[10:11], v[24:25] op_sel_hi:[1,0]
v_pk_mul_f32 v[12:13], v[12:13], v[24:25] op_sel_hi:[1,0]
v_pk_mul_f32 v[14:15], v[14:15], v[24:25] op_sel_hi:[1,0]
v_fma_f32 v17, v17, v24, v18
v_add_f32 v17, v17, v19
v_add_f32 v17, v17, v20
v_add_f32 v17, v17, v21
s_waitcnt vmcnt(0)
v_lshlrev_b32 v26, 16, v56
v_and_b32 v27, s25, v56
v_lshlrev_b32 v28, 16, v57
v_and_b32 v29, s25, v57
v_lshlrev_b32 v30, 16, v58
v_and_b32 v31, s25, v58
v_lshlrev_b32 v32, 16, v59
v_and_b32 v33, s25, v59
v_pk_fma_f32 v[8:9], v[26:27], v[18:19], v[8:9] op_sel:[0,0,0] op_sel_hi:[1,0,1]
v_pk_fma_f32 v[10:11], v[28:29], v[18:19], v[10:11] op_sel:[0,0,0] op_sel_hi:[1,0,1]
v_pk_fma_f32 v[12:13], v[30:31], v[18:19], v[12:13] op_sel:[0,0,0] op_sel_hi:[1,0,1]
v_pk_fma_f32 v[14:15], v[32:33], v[18:19], v[14:15] op_sel:[0,0,0] op_sel_hi:[1,0,1]
v_lshlrev_b32 v26, 16, v60
v_and_b32 v27, s25, v60
v_lshlrev_b32 v28, 16, v61
v_and_b32 v29, s25, v61
v_lshlrev_b32 v30, 16, v62
v_and_b32 v31, s25, v62
v_lshlrev_b32 v32, 16, v63
v_and_b32 v33, s25, v63
v_pk_fma_f32 v[8:9], v[26:27], v[18:19], v[8:9] op_sel:[0,1,0] op_sel_hi:[1,1,1]
v_pk_fma_f32 v[10:11], v[28:29], v[18:19], v[10:11] op_sel:[0,1,0] op_sel_hi:[1,1,1]
v_pk_fma_f32 v[12:13], v[30:31], v[18:19], v[12:13] op_sel:[0,1,0] op_sel_hi:[1,1,1]
v_pk_fma_f32 v[14:15], v[32:33], v[18:19], v[14:15] op_sel:[0,1,0] op_sel_hi:[1,1,1]
v_lshlrev_b32 v26, 16, v64
v_and_b32 v27, s25, v64
v_lshlrev_b32 v28, 16, v65
v_and_b32 v29, s25, v65
v_lshlrev_b32 v30, 16, v66
v_and_b32 v31, s25, v66
v_lshlrev_b32 v32, 16, v67
v_and_b32 v33, s25, v67
v_pk_fma_f32 v[8:9], v[26:27], v[20:21], v[8:9] op_sel:[0,0,0] op_sel_hi:[1,0,1]
v_pk_fma_f32 v[10:11], v[28:29], v[20:21], v[10:11] op_sel:[0,0,0] op_sel_hi:[1,0,1]
v_pk_fma_f32 v[12:13], v[30:31], v[20:21], v[12:13] op_sel:[0,0,0] op_sel_hi:[1,0,1]
v_pk_fma_f32 v[14:15], v[32:33], v[20:21], v[14:15] op_sel:[0,0,0] op_sel_hi:[1,0,1]
v_lshlrev_b32 v26, 16, v68
v_and_b32 v27, s25, v68
v_lshlrev_b32 v28, 16, v69
v_and_b32 v29, s25, v69
v_lshlrev_b32 v30, 16, v70
v_and_b32 v31, s25, v70
v_lshlrev_b32 v32, 16, v71
v_and_b32 v33, s25, v71
v_pk_fma_f32 v[8:9], v[26:27], v[20:21], v[8:9] op_sel:[0,1,0] op_sel_hi:[1,1,1]
v_pk_fma_f32 v[10:11], v[28:29], v[20:21], v[10:11] op_sel:[0,1,0] op_sel_hi:[1,1,1]
v_pk_fma_f32 v[12:13], v[30:31], v[20:21], v[12:13] op_sel:[0,1,0] op_sel_hi:[1,1,1]
v_pk_fma_f32 v[14:15], v[32:33], v[20:21], v[14:15] op_sel:[0,1,0] op_sel_hi:[1,1,1]
L_tail:
v_mov_b32 v22, v16
v_mov_b32 v23, v22
s_nop 1
v_permlane16_swap_b32 v22, v23
s_nop 1
v_max_f32 v22, v22, v23
v_mov_b32 v23, v22
s_nop 1
v_permlane32_swap_b32 v22, v23
s_nop 1
v_max_f32 v22, v22, v23
v_sub_f32 v23, v16, v22
v_mul_f32 v23, s24, v23
v_exp_f32 v24, v23
s_nop 0
v_pk_mul_f32 v[8:9], v[8:9], v[24:25] op_sel_hi:[1,0]
v_pk_mul_f32 v[10:11], v[10:11], v[24:25] op_sel_hi:[1,0]
v_pk_mul_f32 v[12:13], v[12:13], v[24:25] op_sel_hi:[1,0]
v_pk_mul_f32 v[14:15], v[14:15], v[24:25] op_sel_hi:[1,0]
v_mul_f32 v23, v17, v24
s_nop 1
v_permlane32_swap_b32 v8, v12
v_permlane32_swap_b32 v9, v13
v_permlane32_swap_b32 v10, v14
v_permlane32_swap_b32 v11, v15
s_nop 1
v_add_f32 v8, v8, v12
v_add_f32 v9, v9, v13
v_add_f32 v10, v10, v14
v_add_f32 v11, v11, v15
s_nop 1
v_permlane16_swap_b32 v8, v10
v_permlane16_swap_b32 v9, v11
s_nop 1
v_add_f32 v8, v8, v10
v_add_f32 v9, v9, v11
v_mov_b32 v24, v23
s_nop 1
v_permlane16_swap_b32 v23, v24
s_nop 1
v_add_f32 v23, v23, v24
v_mov_b32 v24, v23
s_nop 1
v_permlane32_swap_b32 v23, v24
s_nop 1
v_add_f32 v23, v23, v24
v_and_b32 v3, 15, v0
v_lshlrev_b32 v3, 5, v3
v_lshrrev_b32 v38, 4, v0
v_lshl_add_u32 v3, v38, 3, v3
s_lshl_b32 s54, s3, 9
v_add_u32 v3, s54, v3
s_lshl_b32 s54, s3, 3
v_mov_b32 v38, s54
ds_write_b64 v3, v[8:9] offset:2048
ds_write_b64 v38, v[22:23] offset:4096
s_waitcnt lgkmcnt(0)
s_cbranch_execz L_x1
s_barrier
L_x1:
s_cmp_lg_u32 s3, 0
s_cbranch_scc1 L_pub
s_mov_b32 exec_hi, 0
ds_read_b128 v[40:43], v2 offset:4096
ds_read_b128 v[44:47], v2 offset:4112
ds_read_b128 v[48:51], v1 offset:2048
ds_read_b128 v[52:55], v1 offset:2560
ds_read_b128 v[56:59], v1 offset:3072
ds_read_b128 v[60:63], v1 offset:3584
s_waitcnt lgkmcnt(4)
v_max3_f32 v8, v40, v42, v44
v_max_f32 v8, v8, v46
v_sub_f32 v40, v40, v8
v_sub_f32 v42, v42, v8
v_sub_f32 v44, v44, v8
v_sub_f32 v46, v46, v8
v_mul_f32 v40, s24, v40
v_mul_f32 v42, s24, v42
v_mul_f32 v44, s24, v44
v_mul_f32 v46, s24, v46
v_exp_f32 v40, v40
v_exp_f32 v42, v42
v_exp_f32 v44, v44
v_exp_f32 v46, v46
s_waitcnt lgkmcnt(0)
v_mul_f32 v9, v40, v41
v_mul_f32 v12, v40, v48
v_mul_f32 v13, v40, v49
v_mul_f32 v14, v40, v50
v_mul_f32 v15, v40, v51
v_fmac_f32 v9, v42, v43
v_fmac_f32 v12, v42, v52
v_fmac_f32 v13, v42, v53
v_fmac_f32 v14, v42, v54
v_fmac_f32 v15, v42, v55
v_fmac_f32 v9, v44, v45
v_fmac_f32 v12, v44, v56
v_fmac_f32 v13, v44, v57
v_fmac_f32 v14, v44, v58
v_fmac_f32 v15, v44, v59
v_fmac_f32 v9, v46, v47
v_fmac_f32 v12, v46, v60
v_fmac_f32 v13, v46, v61
v_fmac_f32 v14, v46, v62
v_fmac_f32 v15, v46, v63
v_min_u32 v12, -2, v12
v_min_u32 v13, -2, v13
v_min_u32 v14, -2, v14
v_min_u32 v15, -2, v15
v_min_u32 v8, -2, v8
v_min_u32 v9, -2, v9
s_lshl_b32 s54, s2, 9
s_add_u32 s54, s54, 131072
s_lshl_b32 s55, s2, 3
s_add_u32 s55, s55, 262144
s_cbranch_execz L_x2
buffer_store_dwordx4 v[12:15], v1, s[16:19], s54 offen sc1
L_x2:
s_and_b64 exec, 1, s[76:77]
s_cbranch_execz L_x3
buffer_store_dwordx2 v[8:9], v2, s[16:19], s55 offen sc1
L_x3:
s_and_b64 exec, -1, s[76:77]
L_pub:
s_cmp_eq_u32 s6, 1
s_cbranch_scc1 L_ffn
s_cmp_eq_u32 s6, 2
s_cbranch_scc1 L_fin
s_cmp_eq_u32 s6, 3
s_cbranch_scc1 L_stamp
s_lshl_b32 s54, s5, 2
s_add_u32 s54, s54, s3
s_lshl_b32 s55, s54, 6
s_add_u32 s55, s55, 262144
s_lshl_b32 s54, s54, 12
s_add_u32 s54, s54, 131072
s_waitcnt vmcnt(2)
v_lshlrev_b32 v60, 16, v168
v_and_b32 v61, 0xffff0000, v168
v_lshlrev_b32 v62, 16, v169
v_and_b32 v63, 0xffff0000, v169
v_lshlrev_b32 v64, 16, v170
v_and_b32 v65, 0xffff0000, v170
v_lshlrev_b32 v66, 16, v171
v_and_b32 v67, 0xffff0000, v171
v_lshlrev_b32 v68, 16, v172
v_and_b32 v69, 0xffff0000, v172
v_lshlrev_b32 v70, 16, v173
v_and_b32 v71, 0xffff0000, v173
v_lshlrev_b32 v72, 16, v174
v_and_b32 v73, 0xffff0000, v174
v_lshlrev_b32 v74, 16, v175
v_and_b32 v75, 0xffff0000, v175
v_lshlrev_b32 v76, 16, v176
v_and_b32 v77, 0xffff0000, v176
v_lshlrev_b32 v78, 16, v177
v_and_b32 v79, 0xffff0000, v177
v_lshlrev_b32 v80, 16, v178
v_and_b32 v81, 0xffff0000, v178
v_lshlrev_b32 v82, 16, v179
v_and_b32 v83, 0xffff0000, v179
v_lshlrev_b32 v84, 16, v180
v_and_b32 v85, 0xffff0000, v180
v_lshlrev_b32 v86, 16, v181
v_and_b32 v87, 0xffff0000, v181
v_lshlrev_b32 v88, 16, v182
v_and_b32 v89, 0xffff0000, v182
v_lshlrev_b32 v90, 16, v183
v_and_b32 v91, 0xffff0000, v183
v_lshlrev_b32 v92, 16, v184
v_and_b32 v93, 0xffff0000, v184
v_lshlrev_b32 v94, 16, v185
v_and_b32 v95, 0xffff0000, v185
v_lshlrev_b32 v96, 16, v186
v_and_b32 v97, 0xffff0000, v186
v_lshlrev_b32 v98, 16, v187
v_and_b32 v99, 0xffff0000, v187
v_lshlrev_b32 v100, 16, v188
v_and_b32 v101, 0xffff0000, v188
v_lshlrev_b32 v102, 16, v189
v_and_b32 v103, 0xffff0000, v189
v_lshlrev_b32 v104, 16, v190
v_and_b32 v105, 0xffff0000, v190
v_lshlrev_b32 v106, 16, v191
v_and_b32 v107, 0xffff0000, v191
v_lshlrev_b32 v108, 16, v192
v_and_b32 v109, 0xffff0000, v192
v_lshlrev_b32 v110, 16, v193
v_and_b32 v111, 0xffff0000, v193
v_lshlrev_b32 v112, 16, v194
v_and_b32 v113, 0xffff0000, v194
v_lshlrev_b32 v114, 16, v195
v_and_b32 v115, 0xffff0000, v195
v_lshlrev_b32 v116, 16, v196
v_and_b32 v117, 0xffff0000, v196
v_lshlrev_b32 v118, 16, v197
v_and_b32 v119, 0xffff0000, v197
v_lshlrev_b32 v120, 16, v198
v_and_b32 v121, 0xffff0000, v198
v_lshlrev_b32 v122, 16, v199
v_and_b32 v123, 0xffff0000, v199
v_lshlrev_b32 v124, 16, v200
v_and_b32 v125, 0xffff0000, v200
v_lshlrev_b32 v126, 16, v201
v_and_b32 v127, 0xffff0000, v201
v_lshlrev_b32 v128, 16, v202
v_and_b32 v129, 0xffff0000, v202
v_lshlrev_b32 v130, 16, v203
v_and_b32 v131, 0xffff0000, v203
v_lshlrev_b32 v132, 16, v204
v_and_b32 v133, 0xffff0000, v204
v_lshlrev_b32 v134, 16, v205
v_and_b32 v135, 0xffff0000, v205
v_lshlrev_b32 v136, 16, v206
v_and_b32 v137, 0xffff0000, v206
v_lshlrev_b32 v138, 16, v207
v_and_b32 v139, 0xffff0000, v207
v_lshlrev_b32 v140, 16, v208
v_and_b32 v141, 0xffff0000, v208
v_lshlrev_b32 v142, 16, v209
v_and_b32 v143, 0xffff0000, v209
v_lshlrev_b32 v144, 16, v210
v_and_b32 v145, 0xffff0000, v210
v_lshlrev_b32 v146, 16, v211
v_and_b32 v147, 0xffff0000, v211
v_lshlrev_b32 v148, 16, v212
v_and_b32 v149, 0xffff0000, v212
v_lshlrev_b32 v150, 16, v213
v_and_b32 v151, 0xffff0000, v213
v_lshlrev_b32 v152, 16, v214
v_and_b32 v153, 0xffff0000, v214
v_lshlrev_b32 v154, 16, v215
v_and_b32 v155, 0xffff0000, v215
v_lshlrev_b32 v156, 16, v216
v_and_b32 v157, 0xffff0000, v216
v_lshlrev_b32 v158, 16, v217
v_and_b32 v159, 0xffff0000, v217
v_lshlrev_b32 v160, 16, v218
v_and_b32 v161, 0xffff0000, v218
v_lshlrev_b32 v162, 16, v219
v_and_b32 v163, 0xffff0000, v219
v_lshlrev_b32 v168, 16, v220
v_and_b32 v169, 0xffff0000, v220
v_lshlrev_b32 v170, 16, v221
v_and_b32 v171, 0xffff0000, v221
v_lshlrev_b32 v172, 16, v222
v_and_b32 v173, 0xffff0000, v222
v_lshlrev_b32 v174, 16, v223
v_and_b32 v175, 0xffff0000, v223
v_lshlrev_b32 v176, 16, v224
v_and_b32 v177, 0xffff0000, v224
v_lshlrev_b32 v178, 16, v225
v_and_b32 v179, 0xffff0000, v225
v_lshlrev_b32 v180, 16, v226
v_and_b32 v181, 0xffff0000, v226
v_lshlrev_b32 v182, 16, v227
v_and_b32 v183, 0xffff0000, v227
v_lshlrev_b32 v184, 16, v228
v_and_b32 v185, 0xffff0000, v228
v_lshlrev_b32 v186, 16, v229
v_and_b32 v187, 0xffff0000, v229
v_lshlrev_b32 v188, 16, v230
v_and_b32 v189, 0xffff0000, v230
v_lshlrev_b32 v190, 16, v231
v_and_b32 v191, 0xffff0000, v231
v_and_b32 v36, 0xf0, v1
v_lshrrev_b32 v37, 4, v0
v_mul_u32_u24 v37, 20736, v37
v_add_u32 v37, v37, v36
v_lshrrev_b32 v38, 5, v0
v_and_b32 v39, 7, v0
v_xor_b32 v39, v39, v38
v_lshlrev_b32 v39, 3, v39
s_and_b64 s[60:61], -1, s[76:77]
s_and_b64 s[62:63], -1, s[76:77]
s_and_b64 s[64:65], -1, s[76:77]
s_and_b64 s[66:67], -1, s[76:77]
s_and_b64 s[68:69], -1, s[76:77]
G2_top:
s_sub_u32 s79, s79, 1
s_cbranch_scc1 L_end
s_mov_b64 exec, s[60:61]
s_cbranch_execz G2_s0
buffer_load_dwordx4 v[192:195], v1, s[16:19], s54 offen offset:0 sc1
G2_s0:
s_mov_b64 exec, s[62:63]
s_cbranch_execz G2_s1
buffer_load_dwordx4 v[196:199], v1, s[16:19], s54 offen offset:1024 sc1
G2_s1:
s_mov_b64 exec, s[64:65]
s_cbranch_execz G2_s2
buffer_load_dwordx4 v[200:203], v1, s[16:19], s54 offen offset:2048 sc1
G2_s2:
s_mov_b64 exec, s[66:67]
s_cbranch_execz G2_s3
buffer_load_dwordx4 v[204:207], v1, s[16:19], s54 offen offset:3072 sc1
G2_s3:
s_mov_b64 exec, s[68:69]
s_cbranch_execz G2_s4
buffer_load_dwordx2 v[208:209], v39, s[16:19], s55 offen offset:0 sc1
G2_s4:
G2_d:
s_mov_b64 s[58:59], 0
s_waitcnt vmcnt(0)
s_mov_b64 exec, s[60:61]
v_max3_u32 v3, v192, v193, v194
v_max_u32 v3, v3, v195
v_cmp_eq_u32 s[60:61], -1, v3
s_or_b64 s[58:59], s[58:59], s[60:61]
s_mov_b64 exec, s[62:63]
v_max3_u32 v3, v196, v197, v198
v_max_u32 v3, v3, v199
v_cmp_eq_u32 s[62:63], -1, v3
s_or_b64 s[58:59], s[58:59], s[62:63]
s_mov_b64 exec, s[64:65]
v_max3_u32 v3, v200, v201, v202
v_max_u32 v3, v3, v203
v_cmp_eq_u32 s[64:65], -1, v3
s_or_b64 s[58:59], s[58:59], s[64:65]
s_mov_b64 exec, s[66:67]
v_max3_u32 v3, v204, v205, v206
v_max_u32 v3, v3, v207
v_cmp_eq_u32 s[66:67], -1, v3
s_or_b64 s[58:59], s[58:59], s[66:67]
s_mov_b64 exec, s[68:69]
v_max_u32 v3, v208, v209
v_cmp_eq_u32 s[68:69], -1, v3
s_or_b64 s[58:59], s[58:59], s[68:69]
s_cbranch_scc1 G2_top
s_and_b64 exec, -1, s[76:77]
v_mov_b32 v8, v208
s_nop 1
v_max_f32_dpp v8, v8, v8 row_half_mirror row_mask:0xf bank_mask:0xf
s_nop 1
v_max_f32_dpp v8, v8, v8 quad_perm:[1,0,3,2] row_mask:0xf bank_mask:0xf
s_nop 1
v_max_f32_dpp v8, v8, v8 quad_perm:[2,3,0,1] row_mask:0xf bank_mask:0xf
v_sub_f32 v8, v208, v8
v_mul_f32 v8, s24, v8
v_exp_f32 v8, v8
s_nop 0
v_mul_f32 v9, v8, v209
s_nop 1
v_add_f32_dpp v9, v9, v9 row_half_mirror row_mask:0xf bank_mask:0xf
s_nop 1
v_add_f32_dpp v9, v9, v9 quad_perm:[1,0,3,2] row_mask:0xf bank_mask:0xf
s_nop 1
v_add_f32_dpp v9, v9, v9 quad_perm:[2,3,0,1] row_mask:0xf bank_mask:0xf
v_rcp_f32 v9, v9
s_nop 0
v_mul_f32 v8, v8, v9
s_nop 1
v_mul_f32_dpp v12, v8, v192 row_newbcast:0 row_mask:0xf bank_mask:0xf
v_mul_f32_dpp v13, v8, v193 row_newbcast:0 row_mask:0xf bank_mask:0xf
v_mul_f32_dpp v14, v8, v194 row_newbcast:0 row_mask:0xf bank_mask:0xf
v_mul_f32_dpp v15, v8, v195 row_newbcast:0 row_mask:0xf bank_mask:0xf
v_fmac_f32_dpp v12, v8, v196 row_newbcast:2 row_mask:0xf bank_mask:0xf
v_fmac_f32_dpp v13, v8, v197 row_newbcast:2 row_mask:0xf bank_mask:0xf
v_fmac_f32_dpp v14, v8, v198 row_newbcast:2 row_mask:0xf bank_mask:0xf
v_fmac_f32_dpp v15, v8, v199 row_newbcast:2 row_mask:0xf bank_mask:0xf
v_fmac_f32_dpp v12, v8, v200 row_newbcast:4 row_mask:0xf bank_mask:0xf
v_fmac_f32_dpp v13, v8, v201 row_newbcast:4 row_mask:0xf bank_mask:0xf
v_fmac_f32_dpp v14, v8, v202 row_newbcast:4 row_mask:0xf bank_mask:0xf
v_fmac_f32_dpp v15, v8, v203 row_newbcast:4 row_mask:0xf bank_mask:0xf
v_fmac_f32_dpp v12, v8, v204 row_newbcast:6 row_mask:0xf bank_mask:0xf
v_fmac_f32_dpp v13, v8, v205 row_newbcast:6 row_mask:0xf bank_mask:0xf
v_fmac_f32_dpp v14, v8, v206 row_newbcast:6 row_mask:0xf bank_mask:0xf
v_fmac_f32_dpp v15, v8, v207 row_newbcast:6 row_mask:0xf bank_mask:0xf
s_nop 1
v_permlane32_swap_b32 v12, v14
v_permlane32_swap_b32 v13, v15
s_nop 1
v_add_f32 v12, v12, v14
v_add_f32 v13, v13, v15
v_cvt_pk_bf16_f32 v12, v12, v13
v_and_b32 v13, s25, v12
v_lshlrev_b32 v12, 16, v12
v_and_b32 v3, 31, v0
v_lshlrev_b32 v3, 4, v3
v_lshl_add_u32 v3, v38, 3, v3
s_lshl_b32 s54, s3, 9
v_add_u32 v3, s54, v3
ds_write_b64 v3, v[12:13] offset:4608
v_lshrrev_b32 v3, 3, v0
v_lshlrev_b32 v3, 6, v3
v_add_u32 v3, s54, v3
s_waitcnt lgkmcnt(0)
ds_read_b128 v[40:43], v3 offset:4608
ds_read_b128 v[44:47], v3 offset:4624
ds_read_b128 v[48:51], v3 offset:4640
ds_read_b128 v[52:55], v3 offset:4656
v_mov_b32 v8, 0
v_mov_b32 v9, 0
v_mov_b32 v10, 0
v_mov_b32 v11, 0
v_mov_b32 v12, 0
v_mov_b32 v13, 0
v_mov_b32 v14, 0
v_mov_b32 v15, 0
s_waitcnt lgkmcnt(3)
v_pk_fma_f32 v[8:9], v[60:61], v[40:41], v[8:9] op_sel:[0,0,0] op_sel_hi:[1,0,1]
v_pk_fma_f32 v[10:11], v[62:63], v[40:41], v[10:11] op_sel:[0,0,0] op_sel_hi:[1,0,1]
v_pk_fma_f32 v[12:13], v[64:65], v[40:41], v[12:13] op_sel:[0,0,0] op_sel_hi:[1,0,1]
v_pk_fma_f32 v[14:15], v[66:67], v[40:41], v[14:15] op_sel:[0,0,0] op_sel_hi:[1,0,1]
v_pk_fma_f32 v[8:9], v[68:69], v[40:41], v[8:9] op_sel:[0,1,0] op_sel_hi:[1,1,1]
v_pk_fma_f32 v[10:11], v[70:71], v[40:41], v[10:11] op_sel:[0,1,0] op_sel_hi:[1,1,1]
v_pk_fma_f32 v[12:13], v[72:73], v[40:41], v[12:13] op_sel:[0,1,0] op_sel_hi:[1,1,1]
v_pk_fma_f32 v[14:15], v[74:75], v[40:41], v[14:15] op_sel:[0,1,0] op_sel_hi:[1,1,1]
v_pk_fma_f32 v[8:9], v[76:77], v[42:43], v[8:9] op_sel:[0,0,0] op_sel_hi:[1,0,1]
v_pk_fma_f32 v[10:11], v[78:79], v[42:43], v[10:11] op_sel:[0,0,0] op_sel_hi:[1,0,1]
v_pk_fma_f32 v[12:13], v[80:81], v[42:43], v[12:13] op_sel:[0,0,0] op_sel_hi:[1,0,1]
v_pk_fma_f32 v[14:15], v[82:83], v[42:43], v[14:15] op_sel:[0,0,0] op_sel_hi:[1,0,1]
v_pk_fma_f32 v[8:9], v[84:85], v[42:43], v[8:9] op_sel:[0,1,0] op_sel_hi:[1,1,1]
v_pk_fma_f32 v[10:11], v[86:87], v[42:43], v[10:11] op_sel:[0,1,0] op_sel_hi:[1,1,1]
v_pk_fma_f32 v[12:13], v[88:89], v[42:43], v[12:13] op_sel:[0,1,0] op_sel_hi:[1,1,1]
v_pk_fma_f32 v[14:15], v[90:91], v[42:43], v[14:15] op_sel:[0,1,0] op_sel_hi:[1,1,1]
s_waitcnt lgkmcnt(2)
v_pk_fma_f32 v[8:9], v[92:93], v[44:45], v[8:9] op_sel:[0,0,0] op_sel_hi:[1,0,1]
v_pk_fma_f32 v[10:11], v[94:95], v[44:45], v[10:11] op_sel:[0,0,0] op_sel_hi:[1,0,1]
v_pk_fma_f32 v[12:13], v[96:97], v[44:45], v[12:13] op_sel:[0,0,0] op_sel_hi:[1,0,1]
v_pk_fma_f32 v[14:15], v[98:99], v[44:45], v[14:15] op_sel:[0,0,0] op_sel_hi:[1,0,1]
v_pk_fma_f32 v[8:9], v[100:101], v[44:45], v[8:9] op_sel:[0,1,0] op_sel_hi:[1,1,1]
v_pk_fma_f32 v[10:11], v[102:103], v[44:45], v[10:11] op_sel:[0,1,0] op_sel_hi:[1,1,1]
v_pk_fma_f32 v[12:13], v[104:105], v[44:45], v[12:13] op_sel:[0,1,0] op_sel_hi:[1,1,1]
v_pk_fma_f32 v[14:15], v[106:107], v[44:45], v[14:15] op_sel:[0,1,0] op_sel_hi:[1,1,1]
v_pk_fma_f32 v[8:9], v[108:109], v[46:47], v[8:9] op_sel:[0,0,0] op_sel_hi:[1,0,1]
v_pk_fma_f32 v[10:11], v[110:111], v[46:47], v[10:11] op_sel:[0,0,0] op_sel_hi:[1,0,1]
v_pk_fma_f32 v[12:13], v[112:113], v[46:47], v[12:13] op_sel:[0,0,0] op_sel_hi:[1,0,1]
v_pk_fma_f32 v[14:15], v[114:115], v[46:47], v[14:15] op_sel:[0,0,0] op_sel_hi:[1,0,1]
v_pk_fma_f32 v[8:9], v[116:117], v[46:47], v[8:9] op_sel:[0,1,0] op_sel_hi:[1,1,1]
v_pk_fma_f32 v[10:11], v[118:119], v[46:47], v[10:11] op_sel:[0,1,0] op_sel_hi:[1,1,1]
v_pk_fma_f32 v[12:13], v[120:121], v[46:47], v[12:13] op_sel:[0,1,0] op_sel_hi:[1,1,1]
v_pk_fma_f32 v[14:15], v[122:123], v[46:47], v[14:15] op_sel:[0,1,0] op_sel_hi:[1,1,1]
s_waitcnt lgkmcnt(1)
v_pk_fma_f32 v[8:9], v[124:125], v[48:49], v[8:9] op_sel:[0,0,0] op_sel_hi:[1,0,1]
v_pk_fma_f32 v[10:11], v[126:127], v[48:49], v[10:11] op_sel:[0,0,0] op_sel_hi:[1,0,1]
v_pk_fma_f32 v[12:13], v[128:129], v[48:49], v[12:13] op_sel:[0,0,0] op_sel_hi:[1,0,1]
v_pk_fma_f32 v[14:15], v[130:131], v[48:49], v[14:15] op_sel:[0,0,0] op_sel_hi:[1,0,1]
v_pk_fma_f32 v[8:9], v[132:133], v[48:49], v[8:9] op_sel:[0,1,0] op_sel_hi:[1,1,1]
v_pk_fma_f32 v[10:11], v[134:135], v[48:49], v[10:11] op_sel:[0,1,0] op_sel_hi:[1,1,1]
v_pk_fma_f32 v[12:13], v[136:137], v[48:49], v[12:13] op_sel:[0,1,0] op_sel_hi:[1,1,1]
v_pk_fma_f32 v[14:15], v[138:139], v[48:49], v[14:15] op_sel:[0,1,0] op_sel_hi:[1,1,1]
v_pk_fma_f32 v[8:9], v[140:141], v[50:51], v[8:9] op_sel:[0,0,0] op_sel_hi:[1,0,1]
v_pk_fma_f32 v[10:11], v[142:143], v[50:51], v[10:11] op_sel:[0,0,0] op_sel_hi:[1,0,1]
v_pk_fma_f32 v[12:13], v[144:145], v[50:51], v[12:13] op_sel:[0,0,0] op_sel_hi:[1,0,1]
v_pk_fma_f32 v[14:15], v[146:147], v[50:51], v[14:15] op_sel:[0,0,0] op_sel_hi:[1,0,1]
v_pk_fma_f32 v[8:9], v[148:149], v[50:51], v[8:9] op_sel:[0,1,0] op_sel_hi:[1,1,1]
v_pk_fma_f32 v[10:11], v[150:151], v[50:51], v[10:11] op_sel:[0,1,0] op_sel_hi:[1,1,1]
v_pk_fma_f32 v[12:13], v[152:153], v[50:51], v[12:13] op_sel:[0,1,0] op_sel_hi:[1,1,1]
v_pk_fma_f32 v[14:15], v[154:155], v[50:51], v[14:15] op_sel:[0,1,0] op_sel_hi:[1,1,1]
s_waitcnt lgkmcnt(0)
v_pk_fma_f32 v[8:9], v[156:157], v[52:53], v[8:9] op_sel:[0,0,0] op_sel_hi:[1,0,1]
v_pk_fma_f32 v[10:11], v[158:159], v[52:53], v[10:11] op_sel:[0,0,0] op_sel_hi:[1,0,1]
v_pk_fma_f32 v[12:13], v[160:161], v[52:53], v[12:13] op_sel:[0,0,0] op_sel_hi:[1,0,1]
v_pk_fma_f32 v[14:15], v[162:163], v[52:53], v[14:15] op_sel:[0,0,0] op_sel_hi:[1,0,1]
v_pk_fma_f32 v[8:9], v[168:169], v[52:53], v[8:9] op_sel:[0,1,0] op_sel_hi:[1,1,1]
v_pk_fma_f32 v[10:11], v[170:171], v[52:53], v[10:11] op_sel:[0,1,0] op_sel_hi:[1,1,1]
v_pk_fma_f32 v[12:13], v[172:173], v[52:53], v[12:13] op_sel:[0,1,0] op_sel_hi:[1,1,1]
v_pk_fma_f32 v[14:15], v[174:175], v[52:53], v[14:15] op_sel:[0,1,0] op_sel_hi:[1,1,1]
v_pk_fma_f32 v[8:9], v[176:177], v[54:55], v[8:9] op_sel:[0,0,0] op_sel_hi:[1,0,1]
v_pk_fma_f32 v[10:11], v[178:179], v[54:55], v[10:11] op_sel:[0,0,0] op_sel_hi:[1,0,1]
v_pk_fma_f32 v[12:13], v[180:181], v[54:55], v[12:13] op_sel:[0,0,0] op_sel_hi:[1,0,1]
v_pk_fma_f32 v[14:15], v[182:183], v[54:55], v[14:15] op_sel:[0,0,0] op_sel_hi:[1,0,1]
v_pk_fma_f32 v[8:9], v[184:185], v[54:55], v[8:9] op_sel:[0,1,0] op_sel_hi:[1,1,1]
v_pk_fma_f32 v[10:11], v[186:187], v[54:55], v[10:11] op_sel:[0,1,0] op_sel_hi:[1,1,1]
v_pk_fma_f32 v[12:13], v[188:189], v[54:55], v[12:13] op_sel:[0,1,0] op_sel_hi:[1,1,1]
v_pk_fma_f32 v[14:15], v[190:191], v[54:55], v[14:15] op_sel:[0,1,0] op_sel_hi:[1,1,1]
s_nop 1
v_permlane32_swap_b32 v8, v12
v_permlane32_swap_b32 v9, v13
v_permlane32_swap_b32 v10, v14
v_permlane32_swap_b32 v11, v15
s_nop 1
v_add_f32 v8, v8, v12
v_add_f32 v9, v9, v13
v_add_f32 v10, v10, v14
v_add_f32 v11, v11, v15
s_nop 1
v_permlane16_swap_b32 v8, v10
v_permlane16_swap_b32 v9, v11
s_nop 1
v_add_f32 v8, v8, v10
v_add_f32 v9, v9, v11
s_nop 0
v_add_f32_dpp v8, v8, v8 row_ror:8 row_mask:0xf bank_mask:0xf
v_add_f32_dpp v9, v9, v9 row_ror:8 row_mask:0xf bank_mask:0xf
v_and_b32 v3, 7, v0
v_lshlrev_b32 v3, 5, v3
v_lshrrev_b32 v38, 4, v0
v_lshl_add_u32 v3, v38, 3, v3
s_lshl_b32 s54, s3, 8
v_add_u32 v3, s54, v3
ds_write_b64 v3, v[8:9] offset:6656
s_waitcnt lgkmcnt(0)
s_cbranch_execz L_x4
s_barrier
L_x4:
s_cmp_ge_u32 s3, 1
s_cbranch_scc1 L_end
s_and_b64 exec, -1, s[76:77]
ds_read_b128 v[40:43], v36 offset:6656
ds_read_b128 v[44:47], v36 offset:6912
ds_read_b128 v[48:51], v36 offset:7168
ds_read_b128 v[52:55], v36 offset:7424
s_mul_i32 s54, s5, 2560
s_lshl_b32 s55, s7, 8
s_add_u32 s54, s54, s55
s_add_u32 s54, s54, 786432
s_mul_i32 s55, s3, 82944
s_add_u32 s54, s54, s55
s_waitcnt lgkmcnt(0)
v_add_f32 v40, v40, v44
v_add_f32 v48, v48, v52
v_add_f32 v41, v41, v45
v_add_f32 v49, v49, v53
v_add_f32 v42, v42, v46
v_add_f32 v50, v50, v54
v_add_f32 v43, v43, v47
v_add_f32 v51, v51, v55
v_add_f32 v40, v40, v48
v_add_f32 v41, v41, v49
v_add_f32 v42, v42, v50
v_add_f32 v43, v43, v51
v_min_u32 v40, -2, v40
v_min_u32 v41, -2, v41
v_min_u32 v42, -2, v42
v_min_u32 v43, -2, v43
s_cbranch_execz L_x5
buffer_store_dwordx4 v[40:43], v37, s[16:19], s54 offen sc1
L_x5:
s_branch L_stamp
L_ffn:
s_waitcnt vmcnt(2)
v_lshlrev_b32 v136, 16, v168
v_and_b32 v137, 0xffff0000, v168
v_lshlrev_b32 v138, 16, v169
v_and_b32 v139, 0xffff0000, v169
v_lshlrev_b32 v140, 16, v170
v_and_b32 v141, 0xffff0000, v170
v_lshlrev_b32 v142, 16, v171
v_and_b32 v143, 0xffff0000, v171
v_lshlrev_b32 v144, 16, v172
v_and_b32 v145, 0xffff0000, v172
v_lshlrev_b32 v146, 16, v173
v_and_b32 v147, 0xffff0000, v173
v_lshlrev_b32 v148, 16, v174
v_and_b32 v149, 0xffff0000, v174
v_lshlrev_b32 v150, 16, v175
v_and_b32 v151, 0xffff0000, v175
v_lshlrev_b32 v152, 16, v176
v_and_b32 v153, 0xffff0000, v176
v_lshlrev_b32 v154, 16, v177
v_and_b32 v155, 0xffff0000, v177
v_lshlrev_b32 v156, 16, v178
v_and_b32 v157, 0xffff0000, v178
v_lshlrev_b32 v158, 16, v179
v_and_b32 v159, 0xffff0000, v179
v_lshlrev_b32 v160, 16, v180
v_and_b32 v161, 0xffff0000, v180
v_lshlrev_b32 v162, 16, v181
v_and_b32 v163, 0xffff0000, v181
v_lshlrev_b32 v164, 16, v182
v_and_b32 v165, 0xffff0000, v182
v_lshlrev_b32 v166, 16, v183
v_and_b32 v167, 0xffff0000, v183
v_lshlrev_b32 v232, 16, v184
v_and_b32 v233, 0xffff0000, v184
v_lshlrev_b32 v234, 16, v185
v_and_b32 v235, 0xffff0000, v185
v_lshlrev_b32 v236, 16, v186
v_and_b32 v237, 0xffff0000, v186
v_lshlrev_b32 v238, 16, v187
v_and_b32 v239, 0xffff0000, v187
v_lshlrev_b32 v72, 16, v192
v_and_b32 v73, 0xffff0000, v192
v_lshlrev_b32 v74, 16, v193
v_and_b32 v75, 0xffff0000, v193
v_lshlrev_b32 v76, 16, v194
v_and_b32 v77, 0xffff0000, v194
v_lshlrev_b32 v78, 16, v195
v_and_b32 v79, 0xffff0000, v195
v_lshlrev_b32 v80, 16, v196
v_and_b32 v81, 0xffff0000, v196
v_lshlrev_b32 v82, 16, v197
v_and_b32 v83, 0xffff0000, v197
v_lshlrev_b32 v84, 16, v198
v_and_b32 v85, 0xffff0000, v198
v_lshlrev_b32 v86, 16, v199
v_and_b32 v87, 0xffff0000, v199
v_lshlrev_b32 v88, 16, v200
v_and_b32 v89, 0xffff0000, v200
v_lshlrev_b32 v90, 16, v201
v_and_b32 v91, 0xffff0000, v201
v_lshlrev_b32 v92, 16, v202
v_and_b32 v93, 0xffff0000, v202
v_lshlrev_b32 v94, 16, v203
v_and_b32 v95, 0xffff0000, v203
v_lshlrev_b32 v96, 16, v204
v_and_b32 v97, 0xffff0000, v204
v_lshlrev_b32 v98, 16, v205
v_and_b32 v99, 0xffff0000, v205
v_lshlrev_b32 v100, 16, v206
v_and_b32 v101, 0xffff0000, v206
v_lshlrev_b32 v102, 16, v207
v_and_b32 v103, 0xffff0000, v207
v_lshlrev_b32 v104, 16, v208
v_and_b32 v105, 0xffff0000, v208
v_lshlrev_b32 v106, 16, v209
v_and_b32 v107, 0xffff0000, v209
v_lshlrev_b32 v108, 16, v210
v_and_b32 v109, 0xffff0000, v210
v_lshlrev_b32 v110, 16, v211
v_and_b32 v111, 0xffff0000, v211
v_lshlrev_b32 v112, 16, v212
v_and_b32 v113, 0xffff0000, v212
v_lshlrev_b32 v114, 16, v213
v_and_b32 v115, 0xffff0000, v213
v_lshlrev_b32 v116, 16, v214
v_and_b32 v117, 0xffff0000, v214
v_lshlrev_b32 v118, 16, v215
v_and_b32 v119, 0xffff0000, v215
v_lshlrev_b32 v120, 16, v216
v_and_b32 v121, 0xffff0000, v216
v_lshlrev_b32 v122, 16, v217
v_and_b32 v123, 0xffff0000, v217
v_lshlrev_b32 v124, 16, v218
v_and_b32 v125, 0xffff0000, v218
v_lshlrev_b32 v126, 16, v219
v_and_b32 v127, 0xffff0000, v219
v_lshlrev_b32 v128, 16, v220
v_and_b32 v129, 0xffff0000, v220
v_lshlrev_b32 v130, 16, v221
v_and_b32 v131, 0xffff0000, v221
v_lshlrev_b32 v132, 16, v222
v_and_b32 v133, 0xffff0000, v222
v_lshlrev_b32 v134, 16, v223
v_and_b32 v135, 0xffff0000, v223
v_lshlrev_b32 v168, 16, v190
v_and_b32 v169, 0xffff0000, v190
v_lshlrev_b32 v170, 16, v191
v_and_b32 v171, 0xffff0000, v191
v_add_f32 v8, v136, v144
v_add_f32 v24, v152, v160
v_add_f32 v8, v8, v232
v_add_f32 v8, v8, v24
v_add_f32 v9, v137, v145
v_add_f32 v25, v153, v161
v_add_f32 v9, v9, v233
v_add_f32 v9, v9, v25
v_add_f32 v10, v138, v146
v_add_f32 v26, v154, v162
v_add_f32 v10, v10, v234
v_add_f32 v10, v10, v26
v_add_f32 v11, v139, v147
v_add_f32 v27, v155, v163
v_add_f32 v11, v11, v235
v_add_f32 v11, v11, v27
v_add_f32 v12, v140, v148
v_add_f32 v28, v156, v164
v_add_f32 v12, v12, v236
v_add_f32 v12, v12, v28
v_add_f32 v13, v141, v149
v_add_f32 v29, v157, v165
v_add_f32 v13, v13, v237
v_add_f32 v13, v13, v29
v_add_f32 v14, v142, v150
v_add_f32 v30, v158, v166
v_add_f32 v14, v14, v238
v_add_f32 v14, v14, v30
v_add_f32 v15, v143, v151
v_add_f32 v31, v159, v167
v_add_f32 v15, v15, v239
v_add_f32 v15, v15, v31
s_nop 1
v_permlane32_swap_b32 v8, v12
v_permlane32_swap_b32 v9, v13
v_permlane32_swap_b32 v10, v14
v_permlane32_swap_b32 v11, v15
s_nop 1
v_add_f32 v8, v8, v12
v_add_f32 v9, v9, v13
v_add_f32 v10, v10, v14
v_add_f32 v11, v11, v15
s_nop 1
v_permlane16_swap_b32 v8, v10
v_permlane16_swap_b32 v9, v11
s_nop 1
v_add_f32 v8, v8, v10
v_add_f32 v9, v9, v11
s_nop 0
v_add_f32_dpp v8, v8, v8 row_ror:8 row_mask:0xf bank_mask:0xf
v_add_f32_dpp v9, v9, v9 row_ror:8 row_mask:0xf bank_mask:0xf
s_nop 0
v_add_f32_dpp v8, v8, v8 row_ror:4 row_mask:0xf bank_mask:0xf
v_add_f32_dpp v9, v9, v9 row_ror:4 row_mask:0xf bank_mask:0xf
s_nop 0
v_add_f32_dpp v8, v8, v8 row_ror:2 row_mask:0xf bank_mask:0xf
v_add_f32_dpp v9, v9, v9 row_ror:2 row_mask:0xf bank_mask:0xf
v_and_b32 v36, 1, v0
v_lshlrev_b32 v36, 5, v36
v_lshrrev_b32 v38, 4, v0
v_lshl_add_u32 v36, v38, 3, v36
s_lshl_b32 s54, s3, 6
v_add_u32 v36, s54, v36
ds_write_b64 v36, v[8:9] offset:11520
s_mul_i32 s54, s3, 640
v_add_u32 v34, s54, v1
v_lshrrev_b32 v35, 1, v0
v_mul_u32_u24 v35, 20, v35
v_add_u32 v35, s54, v35
s_lshl_b32 s55, s3, 4
v_mov_b32 v37, s55
v_and_b32 v33, 15, v0
v_lshlrev_b32 v33, 2, v33
v_add_u32 v33, 11264, v33
v_lshlrev_b32 v188, 16, v188
v_mov_b32 v21, 0
v_mov_b32 v22, 0
s_and_b32 s55, s7, 3
s_mul_i32 s55, s55, 20736
s_add_u32 s54, s54, s55
s_add_u32 s54, s54, 786432
s_add_u32 s55, s54, 2560*4
v_add_u32 v38, 2560, v1
v_add_u32 v39, 7680, v1
s_mov_b32 s26, -1
s_mov_b32 s27, 0xff
s_and_b64 s[60:61], s[26:27], s[76:77]
s_and_b64 s[62:63], s[26:27], s[76:77]
s_and_b64 s[64:65], s[26:27], s[76:77]
s_and_b64 s[66:67], s[26:27], s[76:77]
s_and_b64 s[68:69], s[26:27], s[76:77]
s_and_b64 s[70:71], s[26:27], s[76:77]
s_and_b64 s[72:73], s[26:27], s[76:77]
s_and_b64 s[74:75], s[26:27], s[76:77]
G3_top:
s_sub_u32 s79, s79, 1
s_cbranch_scc1 L_end
s_mov_b64 exec, s[60:61]
s_cbranch_execz G3_s0
buffer_load_dwordx4 v[192:195], v1, s[16:19], s54 offen offset:0 sc1
G3_s0:
s_mov_b64 exec, s[62:63]
s_cbranch_execz G3_s1
buffer_load_dwordx4 v[196:199], v38, s[16:19], s54 offen offset:0 sc1
G3_s1:
s_mov_b64 exec, s[64:65]
s_cbranch_execz G3_s2
buffer_load_dwordx4 v[200:203], v38, s[16:19], s54 offen offset:2560 sc1
G3_s2:
s_mov_b64 exec, s[66:67]
s_cbranch_execz G3_s3
buffer_load_dwordx4 v[204:207], v39, s[16:19], s54 offen offset:0 sc1
G3_s3:
s_mov_b64 exec, s[68:69]
s_cbranch_execz G3_s4
buffer_load_dwordx4 v[208:211], v1, s[16:19], s55 offen offset:0 sc1
G3_s4:
s_mov_b64 exec, s[70:71]
s_cbranch_execz G3_s5
buffer_load_dwordx4 v[212:215], v38, s[16:19], s55 offen offset:0 sc1
G3_s5:
s_mov_b64 exec, s[72:73]
s_cbranch_execz G3_s6
buffer_load_dwordx4 v[216:219], v38, s[16:19], s55 offen offset:2560 sc1
G3_s6:
s_mov_b64 exec, s[74:75]
s_cbranch_execz G3_s7
buffer_load_dwordx4 v[220:223], v39, s[16:19], s55 offen offset:0 sc1
G3_s7:
G3_d:
s_mov_b64 s[58:59], 0
s_waitcnt vmcnt(0)
s_mov_b64 exec, s[60:61]
v_max3_u32 v3, v192, v193, v194
v_max_u32 v3, v3, v195
v_cmp_eq_u32 s[60:61], -1, v3
s_or_b64 s[58:59], s[58:59], s[60:61]
s_mov_b64 exec, s[62:63]
v_max3_u32 v3, v196, v197, v198
v_max_u32 v3, v3, v199
v_cmp_eq_u32 s[62:63], -1, v3
s_or_b64 s[58:59], s[58:59], s[62:63]
s_mov_b64 exec, s[64:65]
v_max3_u32 v3, v200, v201, v202
v_max_u32 v3, v3, v203
v_cmp_eq_u32 s[64:65], -1, v3
s_or_b64 s[58:59], s[58:59], s[64:65]
s_mov_b64 exec, s[66:67]
v_max3_u32 v3, v204, v205, v206
v_max_u32 v3, v3, v207
v_cmp_eq_u32 s[66:67], -1, v3
s_or_b64 s[58:59], s[58:59], s[66:67]
s_mov_b64 exec, s[68:69]
v_max3_u32 v3, v208, v209, v210
v_max_u32 v3, v3, v211
v_cmp_eq_u32 s[68:69], -1, v3
s_or_b64 s[58:59], s[58:59], s[68:69]
s_mov_b64 exec, s[70:71]
v_max3_u32 v3, v212, v213, v214
v_max_u32 v3, v3, v215
v_cmp_eq_u32 s[70:71], -1, v3
s_or_b64 s[58:59], s[58:59], s[70:71]
s_mov_b64 exec, s[72:73]
v_max3_u32 v3, v216, v217, v218
v_max_u32 v3, v3, v219
v_cmp_eq_u32 s[72:73], -1, v3
s_or_b64 s[58:59], s[58:59], s[72:73]
s_mov_b64 exec, s[74:75]
v_max3_u32 v3, v220, v221, v222
v_max_u32 v3, v3, v223
v_cmp_eq_u32 s[74:75], -1, v3
s_or_b64 s[58:59], s[58:59], s[74:75]
s_cbranch_scc1 G3_top
s_and_b64 exec, s[26:27], s[76:77]
v_pk_add_f32 v[40:41], v[192:193], v[208:209]
v_pk_add_f32 v[42:43], v[194:195], v[210:211]
v_pk_add_f32 v[44:45], v[196:197], v[212:213]
v_pk_add_f32 v[46:47], v[198:199], v[214:215]
v_pk_add_f32 v[48:49], v[200:201], v[216:217]
v_pk_add_f32 v[50:51], v[202:203], v[218:219]
v_pk_add_f32 v[52:53], v[204:205], v[220:221]
v_pk_add_f32 v[54:55], v[206:207], v[222:223]
v_pk_add_f32 v[40:41], v[40:41], v[48:49]
v_pk_add_f32 v[42:43], v[42:43], v[50:51]
v_pk_add_f32 v[44:45], v[44:45], v[52:53]
v_pk_add_f32 v[46:47], v[46:47], v[54:55]
v_pk_add_f32 v[40:41], v[40:41], v[44:45]
v_pk_add_f32 v[42:43], v[42:43], v[46:47]
v_cvt_pk_bf16_f32 v40, v40, v41
v_cvt_pk_bf16_f32 v41, v42, v43
v_lshlrev_b32 v44, 16, v40
v_and_b32 v45, 0xffff0000, v40
v_lshlrev_b32 v46, 16, v41
v_and_b32 v47, 0xffff0000, v41
v_add_f32 v44, v44, v168
v_add_f32 v45, v45, v169
v_add_f32 v46, v46, v170
v_add_f32 v47, v47, v171
v_cvt_pk_bf16_f32 v40, v44, v45
v_cvt_pk_bf16_f32 v41, v46, v47
v_lshlrev_b32 v44, 16, v40
v_and_b32 v45, 0xffff0000, v40
v_lshlrev_b32 v46, 16, v41
v_and_b32 v47, 0xffff0000, v41
v_readfirstlane_b32 s54, v44
s_nop 1
v_subrev_f32 v44, s54, v44
v_subrev_f32 v45, s54, v45
v_subrev_f32 v46, s54, v46
v_subrev_f32 v47, s54, v47
ds_write_b128 v34, v[44:47] offset:8192
v_add_f32 v21, v44, v45
v_mul_f32 v22, v44, v44
v_add_f32 v21, v21, v46
v_fmac_f32 v22, v45, v45
v_add_f32 v21, v21, v47
v_fmac_f32 v22, v46, v46
v_fmac_f32 v22, v47, v47
s_mov_b64 exec, s[76:77]
s_waitcnt lgkmcnt(0)
ds_read_b32 v24, v35 offset:8192
ds_read_b32 v25, v35 offset:8196
ds_read_b32 v26, v35 offset:8200
ds_read_b32 v27, v35 offset:8204
ds_read_b32 v28, v35 offset:8208
v_permlane32_swap_b32 v21, v22
s_nop 0
v_add_f32 v21, v21, v22
s_nop 1
v_add_f32_dpp v21, v21, v21 row_ror:8 row_mask:0xf bank_mask:0xf
s_nop 1
v_add_f32_dpp v21, v21, v21 row_ror:4 row_mask:0xf bank_mask:0xf
s_nop 1
v_add_f32_dpp v21, v21, v21 row_ror:2 row_mask:0xf bank_mask:0xf
s_nop 1
v_add_f32_dpp v21, v21, v21 row_ror:1 row_mask:0xf bank_mask:0xf
v_mov_b32 v22, v21
v_mov_b32 v20, s54
s_nop 0
v_permlane16_swap_b32 v21, v22
s_nop 0
v_add_f32 v21, v21, v22
v_mov_b32 v22, v21
s_nop 1
v_permlane32_swap_b32 v21, v22
s_waitcnt lgkmcnt(0)
ds_write_b96 v37, v[20:22] offset:11776
v_pk_mul_f32 v[8:9], v[136:137], v[24:25] op_sel_hi:[1,0]
v_pk_mul_f32 v[10:11], v[138:139], v[24:25] op_sel_hi:[1,0]
v_pk_mul_f32 v[12:13], v[140:141], v[24:25] op_sel_hi:[1,0]
v_pk_mul_f32 v[14:15], v[142:143], v[24:25] op_sel_hi:[1,0]
v_pk_fma_f32 v[8:9], v[144:145], v[24:25], v[8:9] op_sel:[0,1,0] op_sel_hi:[1,1,1]
v_pk_fma_f32 v[10:11], v[146:147], v[24:25], v[10:11] op_sel:[0,1,0] op_sel_hi:[1,1,1]
v_pk_fma_f32 v[12:13], v[148:149], v[24:25], v[12:13] op_sel:[0,1,0] op_sel_hi:[1,1,1]
v_pk_fma_f32 v[14:15], v[150:151], v[24:25], v[14:15] op_sel:[0,1,0] op_sel_hi:[1,1,1]
v_pk_fma_f32 v[8:9], v[152:153], v[26:27], v[8:9] op_sel:[0,0,0] op_sel_hi:[1,0,1]
v_pk_fma_f32 v[10:11], v[154:155], v[26:27], v[10:11] op_sel:[0,0,0] op_sel_hi:[1,0,1]
v_pk_fma_f32 v[12:13], v[156:157], v[26:27], v[12:13] op_sel:[0,0,0] op_sel_hi:[1,0,1]
v_pk_fma_f32 v[14:15], v[158:159], v[26:27], v[14:15] op_sel:[0,0,0] op_sel_hi:[1,0,1]
v_pk_fma_f32 v[8:9], v[160:161], v[26:27], v[8:9] op_sel:[0,1,0] op_sel_hi:[1,1,1]
v_pk_fma_f32 v[10:11], v[162:163], v[26:27], v[10:11] op_sel:[0,1,0] op_sel_hi:[1,1,1]
v_pk_fma_f32 v[12:13], v[164:165], v[26:27], v[12:13] op_sel:[0,1,0] op_sel_hi:[1,1,1]
v_pk_fma_f32 v[14:15], v[166:167], v[26:27], v[14:15] op_sel:[0,1,0] op_sel_hi:[1,1,1]
v_pk_fma_f32 v[8:9], v[232:233], v[28:29], v[8:9] op_sel:[0,0,0] op_sel_hi:[1,0,1]
v_pk_fma_f32 v[10:11], v[234:235], v[28:29], v[10:11] op_sel:[0,0,0] op_sel_hi:[1,0,1]
v_pk_fma_f32 v[12:13], v[236:237], v[28:29], v[12:13] op_sel:[0,0,0] op_sel_hi:[1,0,1]
v_pk_fma_f32 v[14:15], v[238:239], v[28:29], v[14:15] op_sel:[0,0,0] op_sel_hi:[1,0,1]
s_nop 1
v_permlane32_swap_b32 v8, v12
v_permlane32_swap_b32 v9, v13
v_permlane32_swap_b32 v10, v14
v_permlane32_swap_b32 v11, v15
s_nop 1
v_add_f32 v8, v8, v12
v_add_f32 v9, v9, v13
v_add_f32 v10, v10, v14
v_add_f32 v11, v11, v15
s_nop 1
v_permlane16_swap_b32 v8, v10
v_permlane16_swap_b32 v9, v11
s_nop 1
v_add_f32 v8, v8, v10
v_add_f32 v9, v9, v11
s_nop 0
v_add_f32_dpp v8, v8, v8 row_ror:8 row_mask:0xf bank_mask:0xf
v_add_f32_dpp v9, v9, v9 row_ror:8 row_mask:0xf bank_mask:0xf
s_nop 0
v_add_f32_dpp v8, v8, v8 row_ror:4 row_mask:0xf bank_mask:0xf
v_add_f32_dpp v9, v9, v9 row_ror:4 row_mask:0xf bank_mask:0xf
s_nop 0
v_add_f32_dpp v8, v8, v8 row_ror:2 row_mask:0xf bank_mask:0xf
v_add_f32_dpp v9, v9, v9 row_ror:2 row_mask:0xf bank_mask:0xf
ds_write_b64 v36, v[8:9] offset:11264
s_waitcnt lgkmcnt(0)
s_cbranch_execz L_y1
s_barrier
L_y1:
ds_read_b96 v[40:42], v2 offset:11776
ds_read_b96 v[44:46], v2 offset:11792
ds_read_b96 v[48:50], v2 offset:11808
ds_read_b96 v[52:54], v2 offset:11824
ds_read2_b32 v[56:57], v33 offset0:0 offset1:64
ds_read2_b32 v[58:59], v33 offset0:16 offset1:80
ds_read2_b32 v[60:61], v33 offset0:32 offset1:96
ds_read2_b32 v[62:63], v33 offset0:48 offset1:112
s_waitcnt lgkmcnt(4)
v_add_f32 v8, v40, v44
v_add_f32 v9, v48, v52
v_add_f32 v10, v41, v45
v_add_f32 v11, v49, v53
v_add_f32 v8, v8, v9
v_add_f32 v10, v10, v11
v_mul_f32 v10, 0x3acccccd, v10
v_fmac_f32 v10, 0.25, v8
s_mov_b32 s54, 0x43200000
v_sub_f32 v40, v10, v40
v_sub_f32 v44, v10, v44
v_sub_f32 v48, v10, v48
v_sub_f32 v52, v10, v52
v_mul_f32 v43, s54, v40
v_mul_f32 v47, s54, v44
v_mul_f32 v51, s54, v48
v_mul_f32 v55, s54, v52
v_fmac_f32 v43, -2.0, v41
v_fmac_f32 v47, -2.0, v45
v_fmac_f32 v51, -2.0, v49
v_fmac_f32 v55, -2.0, v53
v_fmac_f32 v42, v43, v40
v_fmac_f32 v46, v47, v44
v_fmac_f32 v50, v51, v48
v_fmac_f32 v54, v55, v52
v_add_f32 v8, v42, v46
v_add_f32 v9, v50, v54
v_add_f32 v8, v8, v9
v_mul_f32 v8, 0x3acccccd, v8
v_max_f32 v8, 0, v8
v_cvt_pk_bf16_f32 v8, v8, v8
v_and_b32 v8, 0xffff0000, v8
v_add_f32 v8, 0x3727c5ac, v8
v_cvt_pk_bf16_f32 v8, v8, v8
v_and_b32 v8, 0xffff0000, v8
v_sqrt_f32 v8, v8
v_mov_b32 v11, v10
v_cvt_pk_bf16_f32 v10, v10, v10
v_and_b32 v10, 0xffff0000, v10
v_cvt_pk_bf16_f32 v8, v8, v8
v_and_b32 v8, 0xffff0000, v8
v_rcp_f32 v9, v8
v_sub_f32 v11, v10, v11
s_waitcnt lgkmcnt(0)
v_add_f32 v40, v40, v11
v_add_f32 v44, v44, v11
v_add_f32 v48, v48, v11
v_add_f32 v52, v52, v11
v_fma_f32 v56, -v40, v57, v56
v_fma_f32 v58, -v44, v59, v58
v_fma_f32 v60, -v48, v61, v60
v_fma_f32 v62, -v52, v63, v62
v_add_f32 v8, v56, v58
v_add_f32 v10, v60, v62
v_add_f32 v8, v8, v10
v_mul_f32 v8, v8, v9
v_cvt_pk_bf16_f32 v8, v8, v8
v_and_b32 v8, 0xffff0000, v8
v_add_f32 v8, v8, v188
v_cvt_pk_bf16_f32 v8, v8, v8
v_and_b32 v8, 0xffff0000, v8
v_mul_f32 v9, v8, v8
v_mul_f32 v9, 0x3d372713, v9
v_fma_f32 v9, v9, v8, v8
v_mul_f32 v9, 0xc0135761, v9
v_exp_f32 v9, v9
s_nop 0
v_add_f32 v9, 1.0, v9
v_rcp_f32 v9, v9
s_nop 0
v_mul_f32 v8, v8, v9
v_cvt_pk_bf16_f32 v8, v8, v8
v_and_b32 v8, 0xffff0000, v8
s_nop 1
v_mul_f32_dpp v12, v8, v72 row_newbcast:0 row_mask:0xf bank_mask:0xf
v_mul_f32_dpp v13, v8, v73 row_newbcast:0 row_mask:0xf bank_mask:0xf
v_mul_f32_dpp v14, v8, v74 row_newbcast:0 row_mask:0xf bank_mask:0xf
v_mul_f32_dpp v15, v8, v75 row_newbcast:0 row_mask:0xf bank_mask:0xf
v_fmac_f32_dpp v12, v8, v76 row_newbcast:1 row_mask:0xf bank_mask:0xf
v_fmac_f32_dpp v13, v8, v77 row_newbcast:1 row_mask:0xf bank_mask:0xf
v_fmac_f32_dpp v14, v8, v78 row_newbcast:1 row_mask:0xf bank_mask:0xf
v_fmac_f32_dpp v15, v8, v79 row_newbcast:1 row_mask:0xf bank_mask:0xf
v_fmac_f32_dpp v12, v8, v80 row_newbcast:2 row_mask:0xf bank_mask:0xf
v_fmac_f32_dpp v13, v8, v81 row_newbcast:2 row_mask:0xf bank_mask:0xf
v_fmac_f32_dpp v14, v8, v82 row_newbcast:2 row_mask:0xf bank_mask:0xf
v_fmac_f32_dpp v15, v8, v83 row_newbcast:2 row_mask:0xf bank_mask:0xf
v_fmac_f32_dpp v12, v8, v84 row_newbcast:3 row_mask:0xf bank_mask:0xf
v_fmac_f32_dpp v13, v8, v85 row_newbcast:3 row_mask:0xf bank_mask:0xf
v_fmac_f32_dpp v14, v8, v86 row_newbcast:3 row_mask:0xf bank_mask:0xf
v_fmac_f32_dpp v15, v8, v87 row_newbcast:3 row_mask:0xf bank_mask:0xf
v_fmac_f32_dpp v12, v8, v88 row_newbcast:4 row_mask:0xf bank_mask:0xf
v_fmac_f32_dpp v13, v8, v89 row_newbcast:4 row_mask:0xf bank_mask:0xf
v_fmac_f32_dpp v14, v8, v90 row_newbcast:4 row_mask:0xf bank_mask:0xf
v_fmac_f32_dpp v15, v8, v91 row_newbcast:4 row_mask:0xf bank_mask:0xf
v_fmac_f32_dpp v12, v8, v92 row_newbcast:5 row_mask:0xf bank_mask:0xf
v_fmac_f32_dpp v13, v8, v93 row_newbcast:5 row_mask:0xf bank_mask:0xf
v_fmac_f32_dpp v14, v8, v94 row_newbcast:5 row_mask:0xf bank_mask:0xf
v_fmac_f32_dpp v15, v8, v95 row_newbcast:5 row_mask:0xf bank_mask:0xf
v_fmac_f32_dpp v12, v8, v96 row_newbcast:6 row_mask:0xf bank_mask:0xf
v_fmac_f32_dpp v13, v8, v97 row_newbcast:6 row_mask:0xf bank_mask:0xf
v_fmac_f32_dpp v14, v8, v98 row_newbcast:6 row_mask:0xf bank_mask:0xf
v_fmac_f32_dpp v15, v8, v99 row_newbcast:6 row_mask:0xf bank_mask:0xf
v_fmac_f32_dpp v12, v8, v100 row_newbcast:7 row_mask:0xf bank_mask:0xf
v_fmac_f32_dpp v13, v8, v101 row_newbcast:7 row_mask:0xf bank_mask:0xf
v_fmac_f32_dpp v14, v8, v102 row_newbcast:7 row_mask:0xf bank_mask:0xf
v_fmac_f32_dpp v15, v8, v103 row_newbcast:7 row_mask:0xf bank_mask:0xf
v_fmac_f32_dpp v12, v8, v104 row_newbcast:8 row_mask:0xf bank_mask:0xf
v_fmac_f32_dpp v13, v8, v105 row_newbcast:8 row_mask:0xf bank_mask:0xf
v_fmac_f32_dpp v14, v8, v106 row_newbcast:8 row_mask:0xf bank_mask:0xf
v_fmac_f32_dpp v15, v8, v107 row_newbcast:8 row_mask:0xf bank_mask:0xf
v_fmac_f32_dpp v12, v8, v108 row_newbcast:9 row_mask:0xf bank_mask:0xf
v_fmac_f32_dpp v13, v8, v109 row_newbcast:9 row_mask:0xf bank_mask:0xf
v_fmac_f32_dpp v14, v8, v110 row_newbcast:9 row_mask:0xf bank_mask:0xf
v_fmac_f32_dpp v15, v8, v111 row_newbcast:9 row_mask:0xf bank_mask:0xf
v_fmac_f32_dpp v12, v8, v112 row_newbcast:10 row_mask:0xf bank_mask:0xf
v_fmac_f32_dpp v13, v8, v113 row_newbcast:10 row_mask:0xf bank_mask:0xf
v_fmac_f32_dpp v14, v8, v114 row_newbcast:10 row_mask:0xf bank_mask:0xf
v_fmac_f32_dpp v15, v8, v115 row_newbcast:10 row_mask:0xf bank_mask:0xf
v_fmac_f32_dpp v12, v8, v116 row_newbcast:11 row_mask:0xf bank_mask:0xf
v_fmac_f32_dpp v13, v8, v117 row_newbcast:11 row_mask:0xf bank_mask:0xf
v_fmac_f32_dpp v14, v8, v118 row_newbcast:11 row_mask:0xf bank_mask:0xf
v_fmac_f32_dpp v15, v8, v119 row_newbcast:11 row_mask:0xf bank_mask:0xf
v_fmac_f32_dpp v12, v8, v120 row_newbcast:12 row_mask:0xf bank_mask:0xf
v_fmac_f32_dpp v13, v8, v121 row_newbcast:12 row_mask:0xf bank_mask:0xf
v_fmac_f32_dpp v14, v8, v122 row_newbcast:12 row_mask:0xf bank_mask:0xf
v_fmac_f32_dpp v15, v8, v123 row_newbcast:12 row_mask:0xf bank_mask:0xf
v_fmac_f32_dpp v12, v8, v124 row_newbcast:13 row_mask:0xf bank_mask:0xf
v_fmac_f32_dpp v13, v8, v125 row_newbcast:13 row_mask:0xf bank_mask:0xf
v_fmac_f32_dpp v14, v8, v126 row_newbcast:13 row_mask:0xf bank_mask:0xf
v_fmac_f32_dpp v15, v8, v127 row_newbcast:13 row_mask:0xf bank_mask:0xf
v_fmac_f32_dpp v12, v8, v128 row_newbcast:14 row_mask:0xf bank_mask:0xf
v_fmac_f32_dpp v13, v8, v129 row_newbcast:14 row_mask:0xf bank_mask:0xf
v_fmac_f32_dpp v14, v8, v130 row_newbcast:14 row_mask:0xf bank_mask:0xf
v_fmac_f32_dpp v15, v8, v131 row_newbcast:14 row_mask:0xf bank_mask:0xf
v_fmac_f32_dpp v12, v8, v132 row_newbcast:15 row_mask:0xf bank_mask:0xf
v_fmac_f32_dpp v13, v8, v133 row_newbcast:15 row_mask:0xf bank_mask:0xf
v_fmac_f32_dpp v14, v8, v134 row_newbcast:15 row_mask:0xf bank_mask:0xf
v_fmac_f32_dpp v15, v8, v135 row_newbcast:15 row_mask:0xf bank_mask:0xf
v_min_u32 v12, -2, v12
v_min_u32 v13, -2, v13
v_min_u32 v14, -2, v14
v_min_u32 v15, -2, v15
s_mul_i32 s54, s7, 2560
s_mul_i32 s55, s3, 640
s_add_u32 s54, s54, s55
s_add_u32 s54, s54, 294912
s_and_b64 exec, s[26:27], s[76:77]
s_cbranch_execz L_x8
buffer_store_dwordx4 v[12:15], v1, s[16:19], s54 offen sc1
L_x8:
s_branch L_stamp
L_fin:
s_lshl_b32 s54, s7, 2
s_add_u32 s54, s54, s3
s_lshl_b32 s57, s54, 4
s_lshl_b32 s54, s54, 5
s_and_b32 s55, s7, 3
s_mul_i32 s55, s55, 20736
s_add_u32 s55, s55, s54
s_add_u32 s55, s55, 786432
s_add_u32 s54, s54, 294912
v_lshrrev_b32 v38, 1, v0
v_mul_u32_u24 v38, 2560, v38
v_and_b32 v39, 1, v0
v_lshl_add_u32 v38, v39, 4, v38
v_mov_b32 v56, 0
v_mov_b32 v57, 0
v_mov_b32 v58, 0
v_mov_b32 v59, 0
s_and_b64 s[60:61], 0xffff, s[76:77]
G4_top:
s_sub_u32 s79, s79, 1
s_cbranch_scc1 L_end
s_mov_b64 exec, s[60:61]
s_cbranch_execz G4_s0
buffer_load_dwordx4 v[56:59], v38, s[16:19], s55 offen offset:0 sc1
G4_s0:
G4_d:
s_mov_b64 s[58:59], 0
s_waitcnt vmcnt(0)
s_mov_b64 exec, s[60:61]
v_max3_u32 v3, v56, v57, v58
v_max_u32 v3, v3, v59
v_cmp_eq_u32 s[60:61], -1, v3
s_or_b64 s[58:59], s[58:59], s[60:61]
s_cbranch_scc1 G4_top
s_and_b64 exec, -1, s[76:77]
v_add_f32_dpp v56, v56, v56 row_ror:8 row_mask:0xf bank_mask:0xf
v_add_f32_dpp v57, v57, v57 row_ror:8 row_mask:0xf bank_mask:0xf
v_add_f32_dpp v58, v58, v58 row_ror:8 row_mask:0xf bank_mask:0xf
v_add_f32_dpp v59, v59, v59 row_ror:8 row_mask:0xf bank_mask:0xf
v_add_f32_dpp v56, v56, v56 row_ror:4 row_mask:0xf bank_mask:0xf
v_add_f32_dpp v57, v57, v57 row_ror:4 row_mask:0xf bank_mask:0xf
v_add_f32_dpp v58, v58, v58 row_ror:4 row_mask:0xf bank_mask:0xf
v_add_f32_dpp v59, v59, v59 row_ror:4 row_mask:0xf bank_mask:0xf
v_add_f32_dpp v56, v56, v56 row_ror:2 row_mask:0xf bank_mask:0xf
v_add_f32_dpp v57, v57, v57 row_ror:2 row_mask:0xf bank_mask:0xf
v_add_f32_dpp v58, v58, v58 row_ror:2 row_mask:0xf bank_mask:0xf
v_add_f32_dpp v59, v59, v59 row_ror:2 row_mask:0xf bank_mask:0xf
v_cvt_pk_bf16_f32 v56, v56, v57
v_cvt_pk_bf16_f32 v57, v58, v59
v_lshlrev_b32 v24, 16, v56
v_and_b32 v25, 0xffff0000, v56
v_lshlrev_b32 v26, 16, v57
v_and_b32 v27, 0xffff0000, v57
v_lshlrev_b32 v28, 16, v168
v_and_b32 v29, 0xffff0000, v168
v_lshlrev_b32 v30, 16, v169
v_and_b32 v31, 0xffff0000, v169
v_lshlrev_b32 v32, 16, v170
v_and_b32 v33, 0xffff0000, v170
v_lshlrev_b32 v34, 16, v171
v_and_b32 v35, 0xffff0000, v171
v_add_f32 v24, v24, v28
v_add_f32 v25, v25, v29
v_add_f32 v26, v26, v30
v_add_f32 v27, v27, v31
v_cvt_pk_bf16_f32 v56, v24, v25
v_cvt_pk_bf16_f32 v57, v26, v27
v_lshlrev_b32 v24, 16, v56
v_and_b32 v25, 0xffff0000, v56
v_lshlrev_b32 v26, 16, v57
v_and_b32 v27, 0xffff0000, v57
s_add_u32 s55, s54, 81920
s_add_u32 s56, s55, 81920
s_add_u32 s26, s56, 81920
v_mov_b32 v72, 0
v_mov_b32 v73, 0
v_mov_b32 v74, 0
v_mov_b32 v75, 0
s_and_b64 s[60:61], -1, s[76:77]
s_and_b64 s[62:63], -1, s[76:77]
s_and_b64 s[64:65], -1, s[76:77]
s_and_b64 s[66:67], 0xffffff, s[76:77]
G5_top:
s_sub_u32 s79, s79, 1
s_cbranch_scc1 L_end
s_mov_b64 exec, s[60:61]
s_cbranch_execz G5_s0
buffer_load_dwordx4 v[60:63], v38, s[16:19], s54 offen offset:0 sc1
G5_s0:
s_mov_b64 exec, s[62:63]
s_cbranch_execz G5_s1
buffer_load_dwordx4 v[64:67], v38, s[16:19], s55 offen offset:0 sc1
G5_s1:
s_mov_b64 exec, s[64:65]
s_cbranch_execz G5_s2
buffer_load_dwordx4 v[68:71], v38, s[16:19], s56 offen offset:0 sc1
G5_s2:
s_mov_b64 exec, s[66:67]
s_cbranch_execz G5_s3
buffer_load_dwordx4 v[72:75], v38, s[16:19], s26 offen offset:0 sc1
G5_s3:
G5_d:
s_mov_b64 s[58:59], 0
s_waitcnt vmcnt(0)
s_mov_b64 exec, s[60:61]
v_max3_u32 v3, v60, v61, v62
v_max_u32 v3, v3, v63
v_cmp_eq_u32 s[60:61], -1, v3
s_or_b64 s[58:59], s[58:59], s[60:61]
s_mov_b64 exec, s[62:63]
v_max3_u32 v3, v64, v65, v66
v_max_u32 v3, v3, v67
v_cmp_eq_u32 s[62:63], -1, v3
s_or_b64 s[58:59], s[58:59], s[62:63]
s_mov_b64 exec, s[64:65]
v_max3_u32 v3, v68, v69, v70
v_max_u32 v3, v3, v71
v_cmp_eq_u32 s[64:65], -1, v3
s_or_b64 s[58:59], s[58:59], s[64:65]
s_mov_b64 exec, s[66:67]
v_max3_u32 v3, v72, v73, v74
v_max_u32 v3, v3, v75
v_cmp_eq_u32 s[66:67], -1, v3
s_or_b64 s[58:59], s[58:59], s[66:67]
s_cbranch_scc1 G5_top
s_and_b64 exec, -1, s[76:77]
v_add_f32 v40, v60, v68
v_add_f32 v41, v61, v69
v_add_f32 v42, v62, v70
v_add_f32 v43, v63, v71
v_add_f32 v44, v64, v72
v_add_f32 v45, v65, v73
v_add_f32 v46, v66, v74
v_add_f32 v47, v67, v75
v_add_f32 v40, v40, v44
v_add_f32 v41, v41, v45
v_add_f32 v42, v42, v46
v_add_f32 v43, v43, v47
v_add_f32_dpp v40, v40, v40 row_ror:8 row_mask:0xf bank_mask:0xf
v_add_f32_dpp v41, v41, v41 row_ror:8 row_mask:0xf bank_mask:0xf
v_add_f32_dpp v42, v42, v42 row_ror:8 row_mask:0xf bank_mask:0xf
v_add_f32_dpp v43, v43, v43 row_ror:8 row_mask:0xf bank_mask:0xf
v_add_f32_dpp v40, v40, v40 row_ror:4 row_mask:0xf bank_mask:0xf
v_add_f32_dpp v41, v41, v41 row_ror:4 row_mask:0xf bank_mask:0xf
v_add_f32_dpp v42, v42, v42 row_ror:4 row_mask:0xf bank_mask:0xf
v_add_f32_dpp v43, v43, v43 row_ror:4 row_mask:0xf bank_mask:0xf
v_add_f32_dpp v40, v40, v40 row_ror:2 row_mask:0xf bank_mask:0xf
v_add_f32_dpp v41, v41, v41 row_ror:2 row_mask:0xf bank_mask:0xf
v_add_f32_dpp v42, v42, v42 row_ror:2 row_mask:0xf bank_mask:0xf
v_add_f32_dpp v43, v43, v43 row_ror:2 row_mask:0xf bank_mask:0xf
v_mov_b32 v44, v40
v_mov_b32 v45, v41
v_mov_b32 v46, v42
v_mov_b32 v47, v43
s_nop 1
v_permlane16_swap_b32 v40, v44
v_permlane16_swap_b32 v41, v45
v_permlane16_swap_b32 v42, v46
v_permlane16_swap_b32 v43, v47
s_nop 1
v_add_f32 v40, v40, v44
v_add_f32 v41, v41, v45
v_add_f32 v42, v42, v46
v_add_f32 v43, v43, v47
v_mov_b32 v44, v40
v_mov_b32 v45, v41
v_mov_b32 v46, v42
v_mov_b32 v47, v43
s_nop 1
v_permlane32_swap_b32 v40, v44
v_permlane32_swap_b32 v41, v45
v_permlane32_swap_b32 v42, v46
v_permlane32_swap_b32 v43, v47
s_nop 1
v_add_f32 v40, v40, v44
v_add_f32 v41, v41, v45
v_add_f32 v42, v42, v46
v_add_f32 v43, v43, v47
v_cvt_pk_bf16_f32 v44, v40, v41
v_cvt_pk_bf16_f32 v45, v42, v43
v_lshlrev_b32 v40, 16, v44
v_and_b32 v41, 0xffff0000, v44
v_lshlrev_b32 v42, 16, v45
v_and_b32 v43, 0xffff0000, v45
v_add_f32 v40, v40, v32
v_add_f32 v41, v41, v33
v_add_f32 v42, v42, v34
v_add_f32 v43, v43, v35
v_cvt_pk_bf16_f32 v44, v40, v41
v_cvt_pk_bf16_f32 v45, v42, v43
v_lshlrev_b32 v40, 16, v44
v_and_b32 v41, 0xffff0000, v44
v_lshlrev_b32 v42, 16, v45
v_and_b32 v43, 0xffff0000, v45
v_add_f32 v40, v40, v24
v_add_f32 v41, v41, v25
v_add_f32 v42, v42, v26
v_add_f32 v43, v43, v27
v_cvt_pk_bf16_f32 v44, v40, v41
v_cvt_pk_bf16_f32 v45, v42, v43
v_lshlrev_b32 v39, 3, v39
s_mov_b32 s20, s32
s_and_b32 s21, s33, 0xffff
s_mov_b32 s22, 1280
s_mov_b32 s23, 0x20000
s_and_b64 exec, 3, s[76:77]
s_cbranch_execz L_x9
buffer_store_dwordx2 v[44:45], v39, s[20:23], s57 offen
L_x9:
L_stamp:
s_cmp_eq_u32 s76, 0
s_cbranch_scc1 L_dryret
L_end:
s_waitcnt vmcnt(0)
s_endpgm
.section .rodata,"a"
.p2align 6
.amdhsa_kernel sequential_preLN__mha_block_cached__dense_activation_gelu__decode_kernel
  .amdhsa_next_free_vgpr 240
  .amdhsa_next_free_sgpr 102
  .amdhsa_accum_offset 240
  .amdhsa_group_segment_fixed_size 0
  .amdhsa_kernarg_size 104
  .amdhsa_user_sgpr_count 2
  .amdhsa_user_sgpr_kernarg_segment_ptr 1
  .amdhsa_system_sgpr_workgroup_id_x 1
.end_amdhsa_kernel
```
